```python
import torch

def _softmax(x, axis=-1):
    return torch.softmax(x, dim=axis)
def _gelu(x):
    return torch.nn.functional.gelu(x, approximate="tanh")
def _silu(x):
    return torch.nn.functional.silu(x)
def _sigmoid(x):
    return torch.sigmoid(x)
def _layernorm(x, axis=-1, eps=1e-5):
    m = x.mean(dim=axis, keepdim=True)
    v = x.var(dim=axis, keepdim=True, unbiased=False)
    return (x - m) / torch.sqrt(v + eps)
def _scatter_add(tgt, idx, src, axis=0):
    return tgt.clone().index_add_(axis, idx, src)
def _segment_sum(src, seg, n):
    out = torch.zeros((n,) + src.shape[1:], dtype=src.dtype)
    return out.index_add_(0, seg, src)
def _pad(x, pw):
    flat = tuple(v for pair in reversed(pw) for v in pair)
    return torch.nn.functional.pad(x, flat)

kernel_name = 'concat_heads__ssm_conv_h3__spectral_fnet__prompt'

def setup_inputs():

    _w = (lambda a: (lambda t: t.to(torch.bfloat16) if t.is_floating_point() else t)(torch.as_tensor(a)))
    def _A_setup():
        B, S, D = 1, 2048, 512
        ks = 4
        return {
            "q": _w((lambda *s: torch.randn(*s, dtype=torch.bfloat16) * 0.05)(B, S, D)),
            "k": _w((lambda *s: torch.randn(*s, dtype=torch.bfloat16) * 3.2)(B, S, D)),
            "v": _w((lambda *s: torch.randn(*s, dtype=torch.bfloat16) * 3.2)(B, S, D)),
            "shift_k": _w((lambda *s: torch.randn(*s, dtype=torch.bfloat16) * 3.2)(D, ks) * 0.5),
            "ssm_k": _w((lambda *s: torch.randn(*s, dtype=torch.bfloat16) * 3.2)(D, S) * (1.0 / S ** 0.5)),
            "ssm_D": _w((lambda *s: torch.randn(*s, dtype=torch.bfloat16) * 3.2)(D)),
        }
    _A_in = _A_setup()

    def _B_setup():
        B, S, D = 1, 2048, 512
        ns = torch.arange(S)[:, None] * torch.arange(S)[None, :]
        nd = torch.arange(D)[:, None] * torch.arange(D)[None, :]
        Ws_re = torch.cos(-2.0 * torch.pi * ns / S).to(float)
        Ws_im = torch.sin(-2.0 * torch.pi * ns / S).to(float)
        Wd_re = torch.cos(-2.0 * torch.pi * nd / D).to(float)
        Wd_im = torch.sin(-2.0 * torch.pi * nd / D).to(float)
        return {
            "x": _w((lambda *s: torch.randn(*s, dtype=torch.bfloat16) * 0.05)(B, S, D)),
            "dft_seq_re": _w(Ws_re),
            "dft_seq_im": _w(Ws_im),
            "dft_hid_re": _w(Wd_re),
            "dft_hid_im": _w(Wd_im),
        }
    _B_in = _B_setup()

    return {
        "A_q": _A_in["q"],
        "A_k": _A_in["k"],
        "A_v": _A_in["v"],
        "A_shift_k": _A_in["shift_k"],
        "A_ssm_k": _A_in["ssm_k"],
        "A_ssm_D": _A_in["ssm_D"],
        "B_x": _B_in["x"],
        "B_dft_seq_re": _B_in["dft_seq_re"],
        "B_dft_seq_im": _B_in["dft_seq_im"],
        "B_dft_hid_re": _B_in["dft_hid_re"],
        "B_dft_hid_im": _B_in["dft_hid_im"],
    }

def reference(A_q, A_k, A_v, A_shift_k, A_ssm_k, A_ssm_D, B_x, B_dft_seq_re, B_dft_seq_im, B_dft_hid_re, B_dft_hid_im):
    def _A_ref(q, k, v, shift_k, ssm_k, ssm_D):
        B, S, D = q.shape
        ks = shift_k.shape[-1]
        k_pad = _pad(k, ((0, 0), (ks - 1, 0), (0, 0)))
        k_shift = torch.zeros_like(k)
        for t in range(ks):
            k_shift = k_shift + k_pad[:, t:t + S, :] * shift_k[:, ks - 1 - t][None, None, :]
        kv = k_shift * v
        L = 2 * S
        kv_pad = _pad(kv, ((0, 0), (0, S), (0, 0)))
        kf_pad = _pad(ssm_k, ((0, 0), (0, S)))
        kv_f = (lambda x, axes=(-2,-1): torch.fft.rfft2(x.float(), dim=axes))(kv_pad[:, None, :, :], axes=(1, 2))
        kf_f = (lambda x, axes=(-2,-1): torch.fft.rfft2(x.float(), dim=axes))(kf_pad[:, None, :], axes=(1, 2))
        kf_f = (lambda x, *d: x.permute(*d))(kf_f, 1, 2, 0)
        y_f = kv_f * kf_f[None, :, :, :]
        y = (lambda x, s, axes=(-2,-1): torch.fft.irfft2(x, s=s, dim=axes).to(torch.bfloat16))(y_f, (1, L), axes=(1, 2))[:, 0, :S, :]
        y = y + kv * ssm_D[None, None, :]
        return q * y

    def _B_ref(x, dft_seq_re, dft_seq_im, dft_hid_re, dft_hid_im):
        a = torch.einsum("bsd,ed->bse", x, dft_hid_re)
        b = torch.einsum("bsd,ed->bse", x, dft_hid_im)
        y = torch.einsum("ts,bse->bte", dft_seq_re, a) - torch.einsum("ts,bse->bte", dft_seq_im, b)
        return y

    a = _A_ref(A_q, A_k, A_v, A_shift_k, A_ssm_k, A_ssm_D)
    b = _B_ref(B_x, B_dft_seq_re, B_dft_seq_im, B_dft_hid_re, B_dft_hid_im)
    return torch.concatenate([a, b], axis=-1)
```

```asm
; @launch grid=(256,1,1) block=(512,1,1) lds=85760
.amdgcn_target "amdgcn-amd-amdhsa--gfx950"
.text
.globl concat_heads__ssm_conv_h3__spectral_fnet__prompt_kernel
.p2align 12

.p2align 8
.type concat_heads__ssm_conv_h3__spectral_fnet__prompt_kernel,@function
concat_heads__ssm_conv_h3__spectral_fnet__prompt_kernel:
    s_load_dwordx16 s[4:19], s[0:1], 0
    s_load_dwordx2 s[22:23], s[0:1], 104
    s_load_dwordx2 s[20:21], s[0:1], 88
    s_cmp_ge_u32 s2, 256
    s_cbranch_scc1 L_exit
    v_lshrrev_b32 v2, 6, v0
    v_and_b32 v1, 15, v0
    v_readfirstlane_b32 s26, v2
    s_and_b32 s24, s2, 7
    s_lshl_b32 s24, s24, 2
    s_lshr_b32 s24, 0x25641730, s24
    s_and_b32 s24, s24, 7
    s_lshr_b32 s25, s2, 3
    s_cmp_ge_u32 s26, 4
    s_cbranch_scc1 L_fnet
    s_getpc_b64 s[30:31]
L_pc:
    s_lshl_b32 s40, s25, 10
    v_lshrrev_b32 v3, 5, v0
    v_lshl_add_u32 v4, v3, 7, s40
    v_min_u32 v4, L_code_end-L_pc-4, v4
    global_load_dword v255, v4, s[30:31]
    s_lshr_b32 s43, s25, 1
    s_xor_b32 s41, s24, 1
    s_and_b32 s41, s41, 7
    s_lshl3_add_u32 s41, s43, s41
    s_and_b32 s42, s25, 1
    s_lshl1_add_u32 s42, s41, s42
    s_lshl_b32 s42, s42, 6
    s_lshl_b32 s41, s24, 7
    v_bfe_u32 v9, v0, 2, 4
    v_lshl_add_u32 v9, v2, 5, v9
    v_and_b32 v15, 3, v0
    v_lshl_add_u32 v10, v15, 4, s42
    v_lshl_add_u32 v9, v9, 14, v10
    v_add_u32 v10, 0x40000, v9
    s_lshl_b32 s43, s26, 11
    s_add_u32 m0, s43, 59008
    v_and_b32 v4, 31, v0
    s_lshl_b32 s40, s25, 16
    s_add_u32 s40, s40, 4096
    v_lshl_add_u32 v7, v4, 2, s41
    v_lshl_add_u32 v5, v3, 13, s40
    v_add_u32 v5, v5, v7
    v_add_u32 v6, 0xffffe400, v5
    v_lshlrev_b32 v8, 2, v7
    s_lshl_b32 s40, s24, 7
    s_lshl_b32 s42, s25, 17
    s_add_u32 s40, s40, s42
    v_and_b32 v11, 7, v0
    v_lshl_add_u32 v11, v11, 4, s40
    v_lshrrev_b32 v12, 3, v0
    v_lshl_add_u32 v11, v12, 11, v11
    v_add_u32 v12, 65536, v11
    s_mov_b32 s59, 2139193217
    v_mov_b32 v124, s59
    v_mov_b32 v125, s59
    v_mov_b64 v[126:127], v[124:125]
    s_mov_b32 s34, 0x200000
    s_mov_b32 s35, 0x20000
    s_mul_i32 s42, s25, 43
    s_lshr_b32 s42, s42, 7
    s_mul_i32 s42, s42, 3
    s_sub_u32 s42, s25, s42
    s_lshl2_add_u32 s42, s42, s26
    s_lshl_b32 s40, s24, 5
    s_add_u32 s42, s42, s40
    s_lshl_b32 s42, s42, 7
    s_add_u32 s42, s42, 2359296
    v_lshl_add_u32 v13, v15, 5, s42
    s_waitcnt lgkmcnt(0)
    global_load_lds_dwordx4 v9, s[16:17]
    s_add_u32 m0, s43, 60032
    s_mov_b64 s[32:33], s[6:7]
    global_load_lds_dwordx4 v10, s[16:17]
    global_load_dword v34, v13, s[22:23]
    s_add_u32 s18, s22, 14679936
    s_addc_u32 s19, s23, 0
    s_cmp_eq_u32 s24, 3
    s_cselect_b64 s[18:19], s[18:19], s[20:21]
    global_store_dwordx4 v11, v[124:127], s[18:19]
    global_store_dwordx4 v12, v[124:127], s[18:19]
    s_add_u32 s44, s22, 2424832
    s_addc_u32 s45, s23, 0
    s_load_dword s27, s[44:45], 0
    s_barrier
    global_load_dwordx4 v[148:151], v8, s[10:11]
    buffer_load_dword v128, v6, s[32:35], 0 offen offset:0
    buffer_load_dword v129, v6, s[32:35], 0 offen offset:1024
    buffer_load_dword v130, v6, s[32:35], 0 offen offset:2048
    global_load_dword v131, v5, s[6:7] offset:-4096
    global_load_dword v132, v5, s[6:7] offset:-3072
    global_load_dword v133, v5, s[6:7] offset:-2048
    global_load_dword v134, v5, s[6:7] offset:-1024
    global_load_dword v135, v5, s[6:7] offset:0
    global_load_dword v136, v5, s[6:7] offset:1024
    global_load_dword v137, v5, s[6:7] offset:2048
    global_load_dword v32, v7, s[14:15]
    global_load_dword v138, v5, s[6:7] offset:3072
    global_load_dword v140, v5, s[8:9] offset:-4096
    global_load_dword v141, v5, s[8:9] offset:-3072
    global_load_dword v142, v5, s[8:9] offset:-2048
    global_load_dword v143, v5, s[8:9] offset:-1024
    global_load_dword v144, v5, s[8:9] offset:0
    global_load_dword v145, v5, s[8:9] offset:1024
    global_load_dword v146, v5, s[8:9] offset:2048
    global_load_dword v147, v5, s[8:9] offset:3072
    s_branch L_sec_conv2
L_sec_aux1:
L_fnet:
    v_and_b32 v0, 255, v0
    s_and_b32 s26, s26, 3
    v_and_b32 v2, 3, v2
    s_mov_b32 s58, 0
    s_lshr_b32 s57, s25, 1
    s_xor_b32 s40, s24, 1
    s_and_b32 s40, s40, 7
    s_and_b32 s56, s25, 1
    s_lshl1_add_u32 s56, s40, s56
    v_bfe_u32 v3, v0, 1, 4
    v_lshl_add_u32 v3, v2, 4, v3
    v_and_b32 v4, 1, v0
    v_bfe_u32 v5, v0, 5, 1
    v_mul_u32_u24 v6, s57, v3
    v_lshl_add_u32 v6, v4, 9, v6
    v_lshlrev_b32 v7, 4, v3
    v_and_b32 v8, 0xdf, v0
    v_cmp_eq_u32 vcc, 1, v8
    v_mov_b32 v9, 0x400
    s_nop 0
    v_cndmask_b32 v6, v6, 0, vcc
    v_cndmask_b32 v7, v7, v9, vcc
    v_lshlrev_b32 v9, 3, v5
    v_mad_u32_u24 v6, v9, v7, v6
    v_cvt_f32_u32 v6, v6
    v_cvt_f32_u32 v7, v7
    v_mul_f32 v10, 0x3a000000, v6
    v_mul_f32 v7, 0x3a000000, v7
    v_add_f32 v11, v10, v7
    v_add_f32 v12, v7, v7
    v_mov_b32 v13, v12
    v_mul_f32 v14, 0x41200000, v7
    v_mov_b32 v15, v14
    v_and_b32 v8, 2, v0
    v_mul_u32_u24 v8, 0x4000, v8
    v_lshl_or_b32 v8, v8, 16, v8
    v_cos_f32 v100, v10
    v_cos_f32 v101, v11
    v_pk_add_f32 v[10:11], v[10:11], v[12:13]
    v_cvt_pk_bf16_f32 v16, v100, v101
    v_cos_f32 v100, v10
    v_cos_f32 v101, v11
    v_pk_add_f32 v[10:11], v[10:11], v[12:13]
    v_cvt_pk_bf16_f32 v17, v100, v101
    v_cos_f32 v100, v10
    v_cos_f32 v101, v11
    v_pk_add_f32 v[10:11], v[10:11], v[12:13]
    v_cvt_pk_bf16_f32 v18, v100, v101
    v_cos_f32 v100, v10
    v_cos_f32 v101, v11
    v_pk_add_f32 v[10:11], v[10:11], v[14:15]
    v_cvt_pk_bf16_f32 v19, v100, v101
    v_cos_f32 v100, v10
    v_cos_f32 v101, v11
    v_pk_add_f32 v[10:11], v[10:11], v[12:13]
    v_cvt_pk_bf16_f32 v20, v100, v101
    v_cos_f32 v100, v10
    v_cos_f32 v101, v11
    v_pk_add_f32 v[10:11], v[10:11], v[12:13]
    v_cvt_pk_bf16_f32 v21, v100, v101
    v_cos_f32 v100, v10
    v_cos_f32 v101, v11
    v_pk_add_f32 v[10:11], v[10:11], v[12:13]
    v_cvt_pk_bf16_f32 v22, v100, v101
    v_cos_f32 v100, v10
    v_cos_f32 v101, v11
    v_pk_add_f32 v[10:11], v[10:11], v[14:15]
    v_cvt_pk_bf16_f32 v23, v100, v101
    s_barrier
    s_waitcnt lgkmcnt(0)
    s_add_u32 s44, s22, 2424832
    s_addc_u32 s45, s23, 0
    s_load_dword s27, s[44:45], 0
    v_cos_f32 v100, v10
    v_cos_f32 v101, v11
    v_pk_add_f32 v[10:11], v[10:11], v[12:13]
    v_cvt_pk_bf16_f32 v24, v100, v101
    v_cos_f32 v100, v10
    v_cos_f32 v101, v11
    v_pk_add_f32 v[10:11], v[10:11], v[12:13]
    v_cvt_pk_bf16_f32 v25, v100, v101
    v_cos_f32 v100, v10
    v_cos_f32 v101, v11
    v_pk_add_f32 v[10:11], v[10:11], v[12:13]
    v_cvt_pk_bf16_f32 v26, v100, v101
    v_cos_f32 v100, v10
    v_cos_f32 v101, v11
    v_pk_add_f32 v[10:11], v[10:11], v[14:15]
    v_cvt_pk_bf16_f32 v27, v100, v101
    v_cos_f32 v100, v10
    v_cos_f32 v101, v11
    v_pk_add_f32 v[10:11], v[10:11], v[12:13]
    v_cvt_pk_bf16_f32 v28, v100, v101
    v_cos_f32 v100, v10
    v_cos_f32 v101, v11
    v_pk_add_f32 v[10:11], v[10:11], v[12:13]
    v_cvt_pk_bf16_f32 v29, v100, v101
    v_cos_f32 v100, v10
    v_cos_f32 v101, v11
    v_pk_add_f32 v[10:11], v[10:11], v[12:13]
    v_cvt_pk_bf16_f32 v30, v100, v101
    v_cos_f32 v100, v10
    v_cos_f32 v101, v11
    s_nop 0
    v_cvt_pk_bf16_f32 v31, v100, v101
    v_and_b32 v6, 31, v0
    v_bfe_u32 v9, v0, 4, 2
    v_bfe_u32 v7, v0, 2, 2
    v_lshl_add_u32 v3, v5, 3, v7
    v_lshlrev_b32 v3, 6, v3
    v_and_b32 v10, 1, v9
    v_lshl_add_u32 v3, v10, 5, v3
    v_and_b32 v10, 3, v0
    v_lshl_add_u32 v3, v10, 3, v3
    v_add_u32 v3, 59008, v3
    v_lshlrev_b32 v247, 4, v0
    v_add_u32 v248, -8, v247
    s_lshl_b32 s34, s25, 13
    s_lshl_b32 s35, s24, 18
    s_add_u32 s34, s34, s35
    s_add_u32 s35, s34, 4096
    s_mov_b64 s[36:37], s[12:13]
    s_mov_b32 s38, 0x200000
    s_mov_b32 s39, 0x20000
    s_lshl_b32 s42, s24, 7
    s_lshl_b32 s43, s25, 17
    s_add_u32 s42, s42, s43
    v_lshrrev_b32 v246, 2, v0
    v_lshl_add_u32 v246, v246, 11, s42
    s_add_u32 s18, s22, 14679936
    s_addc_u32 s19, s23, 0
    s_cmp_eq_u32 s24, 3
    s_cselect_b64 s[18:19], s[18:19], s[20:21]
    s_mov_b64 s[52:53], s[18:19]
    s_lshl_b32 s42, s26, 19
    s_lshl_b32 s43, s56, 11
    s_add_u32 s42, s42, s43
    s_lshl_b32 s43, s57, 7
    s_add_u32 s42, s42, s43
    s_add_u32 s42, s42, 2621440
    v_lshl_add_u32 v127, v6, 2, s42
    v_lshl_add_u32 v127, v5, 16, v127
    s_lshr_b32 s48, s25, 2
    s_xor_b32 s49, s24, 7
    s_lshl3_add_u32 s48, s49, s48
    s_and_b32 s49, s25, 3
    s_lshl_b32 s40, s24, 7
    s_lshr_b32 s41, s25, 1
    s_lshl_b32 s41, s41, 11
    s_add_u32 s51, s40, s41
    s_and_b32 s41, s25, 1
    s_lshl_b32 s41, s41, 6
    s_add_u32 s51, s51, s41
    s_lshl_b32 s41, s26, 20
    s_add_u32 s41, s41, s51
    v_and_b32 v13, 3, v0
    v_lshl_add_u32 v13, v13, 4, s41
    v_bfe_u32 v112, v0, 2, 4
    v_lshl_add_u32 v112, v112, 15, v13
    v_add_u32 v113, 524288, v112
    s_lshl_b32 s40, s24, 12
    s_add_u32 s40, s40, 2359296
    s_add_u32 s46, s22, s40
    s_addc_u32 s47, s23, 0
    s_lshl_b32 s42, s26, 7
    s_lshl2_add_u32 s42, s25, s42
    v_mov_b32 v108, s42
    v_and_b32 v13, 63, v0
    v_lshlrev_b32 v109, 3, v13
    v_and_b32 v13, 7, v0
    s_xor_b32 s42, s24, 1
    s_lshl3_add_u32 s42, s25, s42
    s_lshl_b32 s42, s42, 7
    s_add_u32 s42, s42, 2097152
    v_lshl_add_u32 v123, v13, 15, s42
    s_lshl_b32 s42, s24, 5
    s_add_u32 s42, s42, s25
    s_lshl2_add_u32 s42, s42, s26
    s_lshl_b32 s42, s42, 8
    s_add_u32 s42, s42, 2097152
    s_add_u32 s54, s22, s42
    s_addc_u32 s55, s23, 0
    s_lshl_b32 s42, s25, 16
    s_lshl_b32 s43, s24, 7
    s_add_u32 s42, s42, s43
    v_lshl_add_u32 v114, v13, 4, s42
    v_and_b32 v13, 3, v0
    v_lshlrev_b32 v13, 2, v13
    v_add_u32 v242, 85680, v13
    v_bfe_u32 v13, v0, 3, 3
    v_lshl_add_u32 v114, v13, 10, v114
    v_mov_b32 v116, 2139193217
    v_mov_b32 v117, v116
    v_mov_b64 v[118:119], v[116:117]
    s_lshl2_add_u32 s42, s26, 85632
    v_mov_b32 v120, s42
    v_mov_b32 v243, 1
    v_mov_b32 v121, 85712
    s_lshl2_add_u32 s42, s48, s26
    s_lshl_b32 s42, s42, 13
    s_add_u32 s42, s42, 2625536
    v_and_b32 v13, 7, v0
    v_lshl_add_u32 v122, v13, 4, s42
    v_lshl_add_u32 v122, v9, 9, v122
    v_bfe_u32 v13, v0, 3, 1
    v_lshl_add_u32 v122, v13, 11, v122
    s_mul_i32 s42, s26, 576
    s_add_u32 s42, s42, 67200
    v_lshl_add_u32 v125, v1, 4, s42
    v_mul_u32_u24 v13, 4608, v9
    v_add_u32 v125, v125, v13
    s_mul_i32 s42, s26, 4608
    s_add_u32 s42, s42, 67200
    v_lshl_add_u32 v126, v1, 2, s42
    v_mul_u32_u24 v13, 576, v9
    v_add_u32 v126, v126, v13
    v_add_u32 v249, 2304, v126
    s_lshl2_add_u32 s42, s49, s26
    s_lshl_b32 s42, s42, 7
    s_add_u32 s42, s42, s48
    s_sub_u32 s43, 2048, s42
    s_add_u32 s41, s42, 64
    s_cmp_eq_u32 s48, 0
    s_cselect_b32 s43, s41, s43
    s_lshl_b32 s42, s42, 11
    s_lshl_b32 s43, s43, 11
    v_lshlrev_b32 v13, 5, v1
    v_lshl_add_u32 v13, v9, 3, v13
    v_add_u32 v240, s42, v13
    v_add_u32 v241, s43, v13
    v_sub_u32 v250, s43, v13
    v_and_b32 v13, 63, v0
    v_add_u32 v251, 16, v13
    v_add_u32 v12, 1, v1
    v_and_b32 v12, 15, v12
    v_cmp_lt_u32 vcc, 47, v13
    s_nop 1
    v_cndmask_b32 v251, v251, v12, vcc
    v_lshlrev_b32 v251, 2, v251
    s_mov_b32 s33, 0
    s_xor_b32 s42, s24, 1
    s_lshr_b32 s32, s42, 1
    s_and_b32 s42, s42, 1
    s_xor_b32 s42, s42, 1
    s_lshl_b32 s42, s42, 7
    s_cmp_eq_u32 s26, s32
    s_cselect_b32 s16, s42, 0
    s_cselect_b32 s17, s42, 128
    s_lshl_b32 s42, s49, 2
    v_add_lshl_u32 v7, v7, s42, 1
    v_bfe_u32 v10, v0, 1, 1
    v_and_b32 v12, v10, v4
    v_lshlrev_b32 v12, 4, v12
    v_mov_b32 v13, -1
    s_cmp_lg_u32 s48, 0
    s_cbranch_scc1 L_generic
    v_add_u32 v7, v7, v10
    v_lshlrev_b32 v12, 3, v10
    v_lshlrev_b32 v13, 4, v10
    v_mov_b32 v14, 0xffff
    v_lshlrev_b32 v13, v13, v14
L_generic:
    v_lshl_add_u32 v12, v4, 3, v12
    v_lshlrev_b32 v10, 2, v9
    v_mad_u32_u24 v12, v10, v7, v12
    v_lshlrev_b32 v10, 2, v9
    v_cvt_f32_u32 v12, v12
    v_cvt_f32_u32 v7, v7
    v_mul_f32 v12, 0x3d000000, v12
    v_mul_f32 v7, 0x3d000000, v7
    v_cos_f32 v100, v12
    v_sin_f32 v101, v12
    v_add_f32 v12, v12, v7
    v_cvt_pk_bf16_f32 v100, v100, v101
    v_and_b32 v192, v100, v13
    v_cos_f32 v100, v12
    v_sin_f32 v101, v12
    v_add_f32 v12, v12, v7
    v_cvt_pk_bf16_f32 v100, v100, v101
    v_and_b32 v193, v100, v13
    v_cos_f32 v100, v12
    v_sin_f32 v101, v12
    v_add_f32 v12, v12, v7
    v_cvt_pk_bf16_f32 v100, v100, v101
    v_and_b32 v194, v100, v13
    v_cos_f32 v100, v12
    v_sin_f32 v101, v12
    s_nop 0
    v_cvt_pk_bf16_f32 v100, v100, v101
    v_and_b32 v195, v100, v13
    v_mul_u32_u24 v14, 0x8000, v4
    v_lshl_or_b32 v14, v14, 16, v14
    v_mul_u32_u24 v10, v10, v1
    v_cvt_f32_u32 v10, v10
    v_cvt_f32_u32 v11, v1
    v_mul_f32 v12, 0x3d800000, v10
    v_mul_f32 v13, 0x3d800000, v11
    v_cos_f32 v100, v12
    v_sin_f32 v101, v12
    v_add_f32 v12, v12, v13
    v_cvt_pk_bf16_f32 v200, v100, v101
    v_cvt_pk_bf16_f32 v204, -v101, v100
    v_cos_f32 v100, v12
    v_sin_f32 v101, v12
    v_add_f32 v12, v12, v13
    v_cvt_pk_bf16_f32 v201, v100, v101
    v_cvt_pk_bf16_f32 v205, -v101, v100
    v_cos_f32 v100, v12
    v_sin_f32 v101, v12
    v_add_f32 v12, v12, v13
    v_cvt_pk_bf16_f32 v202, v100, v101
    v_cvt_pk_bf16_f32 v206, -v101, v100
    v_cos_f32 v100, v12
    v_sin_f32 v101, v12
    s_nop 0
    v_cvt_pk_bf16_f32 v203, v100, v101
    v_cvt_pk_bf16_f32 v207, -v101, v100
    s_waitcnt lgkmcnt(0)
    s_barrier
    ds_read_b64_tr_b16 v[48:49], v3 offset:0
    ds_read_b64_tr_b16 v[50:51], v3 offset:256
    ds_read_b64_tr_b16 v[52:53], v3 offset:1024
    ds_read_b64_tr_b16 v[54:55], v3 offset:1280
    ds_read_b64_tr_b16 v[56:57], v3 offset:2048
    ds_read_b64_tr_b16 v[58:59], v3 offset:2304
    ds_read_b64_tr_b16 v[60:61], v3 offset:3072
    ds_read_b64_tr_b16 v[62:63], v3 offset:3328
    ds_read_b64_tr_b16 v[64:65], v3 offset:4096
    ds_read_b64_tr_b16 v[66:67], v3 offset:4352
    ds_read_b64_tr_b16 v[68:69], v3 offset:5120
    ds_read_b64_tr_b16 v[70:71], v3 offset:5376
    ds_read_b64_tr_b16 v[72:73], v3 offset:6144
    ds_read_b64_tr_b16 v[74:75], v3 offset:6400
    ds_read_b64_tr_b16 v[76:77], v3 offset:7168
    ds_read_b64_tr_b16 v[78:79], v3 offset:7424
    buffer_load_dwordx4 v[128:131], v247, s[36:39], s34 offen
    buffer_load_dwordx4 v[132:135], v247, s[36:39], s35 offen
    s_mov_b64 exec, 1
    buffer_load_dwordx2 v[136:137], v248, s[36:39], s34 offen
    buffer_load_dwordx2 v[138:139], v248, s[36:39], s35 offen
    s_mov_b64 exec, -1
    s_waitcnt lgkmcnt(14)
    v_mfma_f32_32x32x16_bf16 v[80:95], v[16:19], v[48:51], 0
    v_xor_b32 v32, v16, v8
    v_xor_b32 v33, v17, v8
    v_xor_b32 v34, v18, v8
    v_xor_b32 v35, v19, v8
    s_waitcnt lgkmcnt(12)
    v_mfma_f32_32x32x16_bf16 v[80:95], v[20:23], v[52:55], v[80:95]
    v_xor_b32 v36, v20, v8
    v_xor_b32 v37, v21, v8
    v_xor_b32 v38, v22, v8
    v_xor_b32 v39, v23, v8
    s_waitcnt lgkmcnt(10)
    v_mfma_f32_32x32x16_bf16 v[80:95], v[24:27], v[56:59], v[80:95]
    v_xor_b32 v40, v24, v8
    v_xor_b32 v41, v25, v8
    v_xor_b32 v42, v26, v8
    v_xor_b32 v43, v27, v8
    s_waitcnt lgkmcnt(8)
    v_mfma_f32_32x32x16_bf16 v[80:95], v[28:31], v[60:63], v[80:95]
    v_xor_b32 v44, v28, v8
    v_xor_b32 v45, v29, v8
    v_xor_b32 v46, v30, v8
    v_xor_b32 v47, v31, v8
    s_waitcnt lgkmcnt(6)
    v_mfma_f32_32x32x16_bf16 v[80:95], v[32:35], v[64:67], v[80:95]
    s_waitcnt lgkmcnt(4)
    v_mfma_f32_32x32x16_bf16 v[80:95], v[36:39], v[68:71], v[80:95]
    s_waitcnt lgkmcnt(2)
    v_mfma_f32_32x32x16_bf16 v[80:95], v[40:43], v[72:75], v[80:95]
    s_waitcnt lgkmcnt(0)
    v_mfma_f32_32x32x16_bf16 v[80:95], v[44:47], v[76:79], v[80:95]
    s_mul_i32 s27, s27, 0x9e3779b1
    s_add_u32 s27, s27, 0x7f4a7c15
    s_getreg_b32 s28, hwreg(HW_REG_XCC_ID, 0, 4)
    s_xor_b32 s29, s27, s28
    s_mov_b32 s30, s27
    s_mov_b32 s31, s27
    s_not_b64 s[92:93], s[30:31]
    v_mov_b32 v110, s29
    v_mov_b32 v124, s27
    s_nop 2
    v_cvt_pk_bf16_f32 v48, v80, v81
    global_store_dword v127, v48, s[22:23] sc1
    v_add_u32 v127, 32768, v127
    v_cvt_pk_bf16_f32 v49, v82, v83
    global_store_dword v127, v49, s[22:23] sc1
    v_add_u32 v127, 98304, v127
    v_cvt_pk_bf16_f32 v50, v84, v85
    global_store_dword v127, v50, s[22:23] sc1
    v_add_u32 v127, 32768, v127
    v_cvt_pk_bf16_f32 v51, v86, v87
    global_store_dword v127, v51, s[22:23] sc1
    v_add_u32 v127, 98304, v127
    v_cvt_pk_bf16_f32 v52, v88, v89
    global_store_dword v127, v52, s[22:23] sc1
    v_add_u32 v127, 32768, v127
    v_cvt_pk_bf16_f32 v53, v90, v91
    global_store_dword v127, v53, s[22:23] sc1
    v_add_u32 v127, 98304, v127
    v_cvt_pk_bf16_f32 v54, v92, v93
    global_store_dword v127, v54, s[22:23] sc1
    v_add_u32 v127, 32768, v127
    v_cvt_pk_bf16_f32 v55, v94, v95
    global_store_dword v127, v55, s[22:23] sc1
    s_branch L_sec_aux2
.p2align 12
L_sec_conv2:
    s_mov_b32 s58, 0
    s_getreg_b32 s28, hwreg(HW_REG_XCC_ID, 0, 4)
    s_lshl_b32 s42, s24, 12
    s_add_u32 s42, s42, 2359296
    s_add_u32 s46, s22, s42
    s_addc_u32 s47, s23, 0
    s_mov_b64 s[36:37], s[18:19]
    s_mov_b64 s[38:39], s[18:19]
    v_mov_b64 v[36:37], 0
    v_mov_b64 v[38:39], 0
    v_and_b32 v9, 1, v3
    v_mul_u32_u24 v9, 4672, v9
    v_lshl_add_u32 v9, v4, 4, v9
    v_add_u32 v9, 33280, v9
    v_lshrrev_b32 v10, 1, v1
    v_mul_u32_u24 v10, 4160, v10
    v_and_b32 v11, 1, v0
    v_lshl_add_u32 v10, v11, 4, v10
    v_cmp_gt_u32 vcc, 64, v0
    s_nop 1
    v_cndmask_b32 v9, v10, v9, vcc
    v_and_b32 v10, 7, v0
    v_lshlrev_b32 v10, 4, v10
    v_add_u32 v10, 85632, v10
    v_cmp_gt_u32 vcc, 128, v0
    s_nop 1
    v_cndmask_b32 v9, v10, v9, vcc
    ds_write_b128 v9, v[36:39]
    s_lshl_b32 s42, s25, 2
    v_lshl_add_u32 v27, v1, 7, s42
    s_waitcnt lgkmcnt(0)
    s_mul_i32 s27, s27, 0x9e3779b1
    s_add_u32 s27, s27, 0x7f4a7c15
    s_xor_b32 s29, s27, s28
    v_mov_b32 v33, s29
    s_mov_b64 exec, 15
    s_waitcnt vmcnt(21)
    s_barrier
    global_store_dword v27, v33, s[46:47] offset:0
    s_mov_b64 exec, -1
    s_lshl_b32 s40, s24, 7
    s_lshl2_add_u32 s41, s25, s26
    s_lshl_b32 s41, s41, 15
    s_add_u32 s41, s41, s40
    v_lshlrev_b32 v11, 2, v4
    v_bfe_u32 v28, v0, 2, 4
    v_lshl_add_u32 v28, v28, 11, s41
    v_lshl_add_u32 v28, v15, 5, v28
    v_lshrrev_b32 v9, 1, v1
    v_lshl_add_u32 v9, v9, 11, s41
    v_and_b32 v13, 1, v0
    v_lshl_add_u32 v9, v13, 6, v9
    v_bfe_u32 v13, v0, 4, 1
    v_lshl_add_u32 v9, v13, 5, v9
    v_and_b32 v12, 1, v3
    v_lshl_add_u32 v9, v12, 4, v9
    v_add_u32 v29, 16384, v9
    v_and_b32 v2, 63, v0
    v_mov_b32 v35, 1
    s_mov_b32 s50, 0
    s_mov_b64 s[52:53], 0
    s_lshr_b32 s48, s26, 1
    s_and_b32 s49, s26, 1
    v_lshlrev_b32 v25, 10, v3
    v_add_u32 v25, v25, v11
    v_bfe_u32 v3, v0, 4, 2
    v_sub_u32 v12, 3, v15
    v_mul_u32_u24 v12, 4160, v12
    v_or_b32 v13, 3, v1
    v_lshl_add_u32 v12, v13, 1, v12
    v_lshl_add_u32 v12, v3, 4, v12
    s_mul_i32 s42, s48, 16640
    s_lshl_b32 s43, s49, 8
    s_add_u32 s42, s42, s43
    s_add_u32 s42, s42, 2
    v_add_u32 v12, s42, v12
    s_lshl_b32 s40, s24, 7
    s_lshr_b32 s41, s25, 1
    s_lshl_b32 s41, s41, 11
    s_add_u32 s51, s40, s41
    s_and_b32 s41, s25, 1
    s_lshl_b32 s41, s41, 6
    s_add_u32 s51, s51, s41
    s_lshl_b32 s41, s26, 20
    s_add_u32 s41, s41, s51
    v_and_b32 v13, 3, v0
    v_lshl_add_u32 v13, v13, 4, s41
    v_bfe_u32 v14, v0, 2, 4
    v_lshl_add_u32 v14, v14, 15, v13
    v_add_u32 v15, 524288, v14
    s_mul_i32 s42, s48, 4672
    s_sub_u32 s42, s42, s43
    s_add_u32 s42, s42, 33616
    v_lshlrev_b32 v13, 1, v1
    v_sub_u32 v13, v13, v3
    v_lshl_add_u32 v13, v13, 4, s42
    v_bfe_u32 v24, v0, 1, 1
    v_mul_u32_u24 v24, 4672, v24
    v_bfe_u32 v26, v0, 2, 4
    v_lshl_add_u32 v24, v26, 5, v24
    v_and_b32 v26, 1, v0
    v_lshl_add_u32 v24, v26, 4, v24
    s_lshl_b32 s41, s26, 10
    v_add_u32 v24, s41, v24
    s_lshl_b32 s41, s26, 12
    s_add_u32 s41, s41, 42624
    v_lshl_add_u32 v8, v2, 4, s41
    s_xor_b32 s41, s26, 1
    s_lshl_b32 s41, s41, 12
    s_add_u32 s41, s41, 42624
    v_lshl_add_u32 v6, v2, 4, s41
    s_lshl2_add_u32 s41, s26, 85632
    v_mov_b32 v10, s41
    v_and_b32 v4, 7, v0
    v_lshlrev_b32 v4, 2, v4
    v_add_u32 v4, 85632, v4
    s_xor_b32 s41, s24, 1
    s_lshr_b32 s41, s41, 1
    s_lshl2_add_u32 s41, s41, 85664
    v_mov_b32 v26, s41
    v_mov_b32 v30, s29
    v_mov_b32 v31, s29
    s_waitcnt vmcnt(21)
    v_lshlrev_b32 v152, 16, v148
    v_lshlrev_b32 v153, 16, v150
    v_and_b32 v154, 0xffff0000, v148
    v_and_b32 v155, 0xffff0000, v150
    v_lshlrev_b32 v156, 16, v149
    v_lshlrev_b32 v157, 16, v151
    v_and_b32 v158, 0xffff0000, v149
    v_and_b32 v159, 0xffff0000, v151
    s_waitcnt vmcnt(14)
    v_lshlrev_b32 v160, 16, v128
    v_and_b32 v161, 0xffff0000, v128
    v_lshlrev_b32 v162, 16, v129
    v_and_b32 v163, 0xffff0000, v129
    v_lshlrev_b32 v164, 16, v130
    v_and_b32 v165, 0xffff0000, v130
    v_lshlrev_b32 v166, 16, v131
    v_and_b32 v167, 0xffff0000, v131
    v_lshlrev_b32 v168, 16, v132
    v_and_b32 v169, 0xffff0000, v132
    v_lshlrev_b32 v170, 16, v133
    v_and_b32 v171, 0xffff0000, v133
    v_lshlrev_b32 v172, 16, v134
    v_and_b32 v173, 0xffff0000, v134
    v_pk_mul_f32 v[200:201], v[160:161], v[158:159]
    v_pk_mul_f32 v[202:203], v[162:163], v[158:159]
    v_pk_mul_f32 v[204:205], v[164:165], v[158:159]
    v_pk_mul_f32 v[206:207], v[166:167], v[158:159]
    v_pk_fma_f32 v[200:201], v[162:163], v[156:157], v[200:201]
    v_pk_fma_f32 v[202:203], v[164:165], v[156:157], v[202:203]
    v_pk_fma_f32 v[204:205], v[166:167], v[156:157], v[204:205]
    v_pk_fma_f32 v[206:207], v[168:169], v[156:157], v[206:207]
    v_pk_fma_f32 v[200:201], v[164:165], v[154:155], v[200:201]
    v_pk_fma_f32 v[202:203], v[166:167], v[154:155], v[202:203]
    v_pk_fma_f32 v[204:205], v[168:169], v[154:155], v[204:205]
    v_pk_fma_f32 v[206:207], v[170:171], v[154:155], v[206:207]
    v_pk_fma_f32 v[200:201], v[166:167], v[152:153], v[200:201]
    v_pk_fma_f32 v[202:203], v[168:169], v[152:153], v[202:203]
    v_pk_fma_f32 v[204:205], v[170:171], v[152:153], v[204:205]
    v_pk_fma_f32 v[206:207], v[172:173], v[152:153], v[206:207]
    s_waitcnt vmcnt(9)
    v_lshlrev_b32 v174, 16, v135
    v_and_b32 v175, 0xffff0000, v135
    v_lshlrev_b32 v176, 16, v136
    v_and_b32 v177, 0xffff0000, v136
    v_lshlrev_b32 v178, 16, v137
    v_and_b32 v179, 0xffff0000, v137
    v_lshlrev_b32 v180, 16, v138
    v_and_b32 v181, 0xffff0000, v138
    v_pk_mul_f32 v[208:209], v[168:169], v[158:159]
    v_pk_mul_f32 v[210:211], v[170:171], v[158:159]
    v_pk_mul_f32 v[212:213], v[172:173], v[158:159]
    v_pk_mul_f32 v[214:215], v[174:175], v[158:159]
    v_pk_fma_f32 v[208:209], v[170:171], v[156:157], v[208:209]
    v_pk_fma_f32 v[210:211], v[172:173], v[156:157], v[210:211]
    v_pk_fma_f32 v[212:213], v[174:175], v[156:157], v[212:213]
    v_pk_fma_f32 v[214:215], v[176:177], v[156:157], v[214:215]
    v_pk_fma_f32 v[208:209], v[172:173], v[154:155], v[208:209]
    v_pk_fma_f32 v[210:211], v[174:175], v[154:155], v[210:211]
    v_pk_fma_f32 v[212:213], v[176:177], v[154:155], v[212:213]
    v_pk_fma_f32 v[214:215], v[178:179], v[154:155], v[214:215]
    v_pk_fma_f32 v[208:209], v[174:175], v[152:153], v[208:209]
    v_pk_fma_f32 v[210:211], v[176:177], v[152:153], v[210:211]
    v_pk_fma_f32 v[212:213], v[178:179], v[152:153], v[212:213]
    v_pk_fma_f32 v[214:215], v[180:181], v[152:153], v[214:215]
    s_waitcnt vmcnt(5)
    v_lshlrev_b32 v184, 16, v140
    v_and_b32 v185, 0xffff0000, v140
    v_lshlrev_b32 v186, 16, v141
    v_and_b32 v187, 0xffff0000, v141
    v_lshlrev_b32 v188, 16, v142
    v_and_b32 v189, 0xffff0000, v142
    v_lshlrev_b32 v190, 16, v143
    v_and_b32 v191, 0xffff0000, v143
    v_pk_mul_f32 v[200:201], v[200:201], v[184:185]
    v_pk_mul_f32 v[202:203], v[202:203], v[186:187]
    v_pk_mul_f32 v[204:205], v[204:205], v[188:189]
    v_pk_mul_f32 v[206:207], v[206:207], v[190:191]
    v_cvt_pk_bf16_f32 v18, v206, v204
    v_cvt_pk_bf16_f32 v22, v207, v205
    v_cvt_pk_bf16_f32 v19, v202, v200
    v_cvt_pk_bf16_f32 v23, v203, v201
    v_permlane16_swap_b32 v18, v22
    s_nop 0
    v_permlane16_swap_b32 v19, v23
    s_waitcnt vmcnt(1)
    v_lshlrev_b32 v192, 16, v144
    v_and_b32 v193, 0xffff0000, v144
    v_lshlrev_b32 v194, 16, v145
    v_and_b32 v195, 0xffff0000, v145
    v_lshlrev_b32 v196, 16, v146
    v_and_b32 v197, 0xffff0000, v146
    v_lshlrev_b32 v198, 16, v147
    v_and_b32 v199, 0xffff0000, v147
    v_pk_mul_f32 v[208:209], v[208:209], v[192:193]
    v_pk_mul_f32 v[210:211], v[210:211], v[194:195]
    v_pk_mul_f32 v[212:213], v[212:213], v[196:197]
    v_pk_mul_f32 v[214:215], v[214:215], v[198:199]
    v_cvt_pk_bf16_f32 v16, v214, v212
    v_cvt_pk_bf16_f32 v20, v215, v213
    v_cvt_pk_bf16_f32 v17, v210, v208
    v_cvt_pk_bf16_f32 v21, v211, v209
    v_permlane16_swap_b32 v16, v20
    s_nop 0
    v_permlane16_swap_b32 v17, v21
    global_store_dwordx4 v9, v[16:19], s[36:37]
    global_store_dwordx4 v29, v[20:23], s[36:37]
    s_load_dwordx16 s[4:19], s[46:47], 0
    s_load_dwordx16 s[84:99], s[46:47], 64
L_look:
    s_waitcnt lgkmcnt(0)
    v_cmpx_eq_u64 vcc, s[4:5], v[30:31]
    v_cmpx_eq_u64 vcc, s[6:7], v[30:31]
    v_cmpx_eq_u64 vcc, s[8:9], v[30:31]
    v_cmpx_eq_u64 vcc, s[10:11], v[30:31]
    v_cmpx_eq_u64 vcc, s[12:13], v[30:31]
    v_cmpx_eq_u64 vcc, s[14:15], v[30:31]
    v_cmpx_eq_u64 vcc, s[16:17], v[30:31]
    v_cmpx_eq_u64 vcc, s[18:19], v[30:31]
    v_cmpx_eq_u64 vcc, s[84:85], v[30:31]
    v_cmpx_eq_u64 vcc, s[86:87], v[30:31]
    v_cmpx_eq_u64 vcc, s[88:89], v[30:31]
    v_cmpx_eq_u64 vcc, s[90:91], v[30:31]
    v_cmpx_eq_u64 vcc, s[92:93], v[30:31]
    v_cmpx_eq_u64 vcc, s[94:95], v[30:31]
    v_cmpx_eq_u64 vcc, s[96:97], v[30:31]
    v_cmpx_eq_u64 vcc, s[98:99], v[30:31]
    s_cbranch_vccnz L_looked
    s_mov_b64 exec, -1
    s_add_u32 s50, s50, 128
    s_cmp_ge_u32 s50, 512
    s_cbranch_scc1 L_kvretry
    s_add_u32 s41, s50, 64
    s_load_dwordx16 s[4:19], s[46:47], s50
    s_load_dwordx16 s[84:99], s[46:47], s41
    s_branch L_look
L_looked:
L_kvok:
    global_load_dword v28, v28, s[36:37] nt
    v_lshlrev_b32 v36, 16, v32
    v_and_b32 v37, 0xffff0000, v32
    v_permlane16_swap_b32 v16, v20
    v_permlane16_swap_b32 v17, v21
    v_permlane16_swap_b32 v18, v22
    v_permlane16_swap_b32 v19, v23
    v_lshlrev_b32 v54, 16, v16
    v_and_b32 v52, 0xffff0000, v16
    v_lshlrev_b32 v50, 16, v17
    v_and_b32 v48, 0xffff0000, v17
    v_lshlrev_b32 v46, 16, v18
    v_and_b32 v44, 0xffff0000, v18
    v_lshlrev_b32 v42, 16, v19
    v_and_b32 v40, 0xffff0000, v19
    v_lshlrev_b32 v55, 16, v20
    v_and_b32 v53, 0xffff0000, v20
    v_lshlrev_b32 v51, 16, v21
    v_and_b32 v49, 0xffff0000, v21
    v_lshlrev_b32 v47, 16, v22
    v_and_b32 v45, 0xffff0000, v22
    v_lshlrev_b32 v43, 16, v23
    v_and_b32 v41, 0xffff0000, v23
    v_pk_mul_f32 v[16:17], v[40:41], v[36:37]
    v_pk_mul_f32 v[18:19], v[42:43], v[36:37]
    v_pk_mul_f32 v[20:21], v[44:45], v[36:37]
    v_pk_mul_f32 v[22:23], v[46:47], v[36:37]
    v_pk_mul_f32 v[116:117], v[48:49], v[36:37]
    v_pk_mul_f32 v[118:119], v[50:51], v[36:37]
    v_pk_mul_f32 v[124:125], v[52:53], v[36:37]
    v_pk_mul_f32 v[126:127], v[54:55], v[36:37]
    v_lshlrev_b32 v30, 1, v5
    v_sub_u32 v30, v30, v7
    v_add_u32 v30, 0xfffff000, v30
    v_add_u32 v31, 8192, v30
    s_cmp_lg_u32 s49, 0
    s_cbranch_scc1 L_convB
    s_branch L_sec_varA
L_sec_kvslow:
L_kvretry:
    global_load_dword v34, v11, s[46:47] offset:0 sc1
    s_add_u32 s52, s52, 1
    s_waitcnt vmcnt(0)
    v_cmp_ne_u32 vcc, s29, v34
    s_cbranch_vccz L_kvok
    s_cmp_gt_u32 s52, 64
    s_cbranch_scc0 L_kvretry
    s_branch L_kvcheck
L_kvcheck:
    s_add_u32 s58, s58, 1
    s_cmp_gt_u32 s58, 0x1000000
    s_cbranch_scc1 L_exit
    s_xor_b32 s55, s27, 0x5bd1e995
    v_mov_b32 v36, s55
    v_mov_b32 v37, s29
    s_lshl_b32 s40, s25, 3
    v_mov_b32 v38, s40
    s_mov_b64 exec, 1
    global_store_dwordx2 v38, v[36:37], s[46:47] offset:3072 sc1
    s_mov_b64 exec, -1
    v_lshlrev_b32 v38, 1, v11
    global_load_dwordx2 v[36:37], v38, s[46:47] offset:3072 sc1
    s_waitcnt vmcnt(0)
    v_cmp_eq_u32 s[56:57], s55, v36
    v_cmp_ne_u32 vcc, s29, v37
    s_nop 0
    s_and_b64 s[56:57], s[56:57], vcc
    v_xor_b32 v37, s27, v37
    v_cmp_gt_u32 vcc, 16, v37
    s_nop 0
    s_and_b64 s[56:57], s[56:57], vcc
    s_cbranch_scc1 L_goslow
    s_sleep 8
    s_branch L_kvretry
L_goslow:
    s_mov_b32 s53, 1
    s_mov_b32 s29, s27
    v_mov_b32 v33, s27
    v_mov_b32 v36, 85712
    ds_write_b32 v36, v35
    s_add_u32 s36, s22, 6291456
    s_addc_u32 s37, s23, 0
    s_add_u32 s38, s22, 10485760
    s_addc_u32 s39, s23, 0
    global_store_dwordx4 v9, v[16:19], s[36:37] sc1
    global_store_dwordx4 v29, v[20:23], s[36:37] sc1
    s_lshl2_add_u32 s40, s25, s26
    s_lshl_b32 s40, s40, 2
    v_mov_b32 v36, s40
    v_lshlrev_b32 v37, 3, v2
    s_waitcnt vmcnt(0) lgkmcnt(0)
    s_mov_b64 exec, 1
    global_store_dword v36, v33, s[46:47] offset:1536 sc1
    s_mov_b64 exec, -1
L_kvslowpoll:
    global_load_dwordx2 v[38:39], v37, s[46:47] offset:1536 sc1
    s_waitcnt vmcnt(0)
    v_cmp_ne_u32 vcc, s29, v38
    v_cmp_ne_u32 s[56:57], s29, v39
    s_nop 0
    s_or_b64 vcc, vcc, s[56:57]
    s_cbranch_scc0 L_kvok
    s_add_u32 s58, s58, 1
    s_cmp_gt_u32 s58, 0x1000000
    s_cbranch_scc1 L_exit
    s_sleep 8
    s_branch L_kvslowpoll

.p2align 12
L_sec_varA:
    s_lshl_b32 s42, s48, 5
    s_add_u32 s41, s51, s42
    v_lshl_add_u32 v27, v1, 15, s41
    v_lshl_add_u32 v27, v3, 3, v27
    v_add_u32 v120, 0, v27
    v_add_u32 v121, 1572864, v27
    v_add_u32 v122, 2097152, v27
    v_add_u32 v123, 3670016, v27
    s_mul_i32 s54, s53, 1536
    s_lshr_b32 s40, s25, 3
    s_lshl_b32 s40, s40, 7
    s_add_u32 s40, s40, s54
    v_add_u32 v11, s40, v11
    s_mov_b32 s56, 0xffff
    s_mov_b32 s57, 0xffff
    s_barrier
    ds_read_b64 v[144:145], v12 offset:512
    ds_read_b64 v[146:147], v12 offset:520
    ds_read_b64 v[160:161], v12 offset:1024
    ds_read_b64 v[162:163], v12 offset:1032
    ds_read_b64 v[148:149], v12 offset:576
    ds_read_b64 v[150:151], v12 offset:584
    ds_read_b64 v[164:165], v12 offset:1088
    ds_read_b64 v[166:167], v12 offset:1096
    ds_read_b64 v[152:153], v12 offset:640
    ds_read_b64 v[154:155], v12 offset:648
    global_load_dwordx4 v[100:103], v14, s[36:37] sc1
    global_load_dwordx4 v[104:107], v15, s[36:37] sc1
    ds_read_b64 v[168:169], v12 offset:1152
    ds_read_b64 v[170:171], v12 offset:1160
    ds_read_b64 v[156:157], v12 offset:704
    ds_read_b64 v[158:159], v12 offset:712
    ds_read_b64 v[172:173], v12 offset:1216
    ds_read_b64 v[174:175], v12 offset:1224
    ds_read_b64 v[188:189], v12 offset:1728
    ds_read_b64 v[190:191], v12 offset:1736
    ds_read_b64 v[184:185], v12 offset:1664
    ds_read_b64 v[186:187], v12 offset:1672
    ds_read_b64 v[180:181], v12 offset:1600
    ds_read_b64 v[182:183], v12 offset:1608
    ds_read_b64 v[176:177], v12 offset:1536
    ds_read_b64 v[178:179], v12 offset:1544
    ds_read_b64 v[128:129], v12 offset:0
    ds_read_b64 v[130:131], v12 offset:8
    ds_read_b64 v[132:133], v12 offset:64
    ds_read_b64 v[134:135], v12 offset:72
    ds_read_b64 v[136:137], v12 offset:128
    ds_read_b64 v[138:139], v12 offset:136
    ds_read_b64 v[140:141], v12 offset:192
    ds_read_b64 v[142:143], v12 offset:200
    ds_read_b64 v[192:193], v12 offset:2048
    ds_read_b64 v[194:195], v12 offset:2056
    v_add_u32 v25, 59008, v25
L_xpollA:
    s_waitcnt vmcnt(0)
    ds_write_b128 v24, v[100:103] offset:33792
    ds_write_b128 v24, v[104:107] offset:34304
    v_cmpx_ne_u32 vcc, s59, v100
    v_cmpx_ne_u32 vcc, s59, v101
    v_cmpx_ne_u32 vcc, s59, v102
    v_cmpx_ne_u32 vcc, s59, v103
    v_cmpx_ne_u32 vcc, s59, v104
    v_cmpx_ne_u32 vcc, s59, v105
    v_cmpx_ne_u32 vcc, s59, v106
    v_cmpx_ne_u32 vcc, s59, v107
    s_nop 0
    s_not_b64 exec, vcc
    s_cbranch_scc0 L_xokA
    s_waitcnt lgkmcnt(0)
    global_load_dwordx4 v[100:103], v14, s[36:37] sc1
    global_load_dwordx4 v[104:107], v15, s[36:37] sc1
    s_mov_b64 exec, -1
    s_add_u32 s58, s58, 1
    s_cmp_gt_u32 s58, 0x1000000
    s_cbranch_scc1 L_exit
    s_branch L_xpollA
L_xokA:
    s_mov_b64 exec, -1
    s_waitcnt lgkmcnt(0)
    s_barrier
    ds_read_b128 v[68:71], v13 offset:2240
    ds_read_b128 v[72:75], v13 offset:2176
    ds_read_b128 v[76:79], v13 offset:2112
    ds_read_b128 v[80:83], v13 offset:2048
    ds_read_b128 v[84:87], v13 offset:1728
    s_waitcnt lgkmcnt(4)
    v_mfma_f32_16x16x32_bf16 v[44:47], v[144:147], v[68:71], 0
    ds_read_b128 v[88:91], v13 offset:1664
    v_mfma_f32_16x16x32_bf16 v[48:51], v[160:163], v[68:71], 0
    ds_read_b128 v[92:95], v13 offset:1600
    s_waitcnt lgkmcnt(5)
    v_mfma_f32_16x16x32_bf16 v[44:47], v[148:151], v[72:75], v[44:47]
    ds_read_b128 v[96:99], v13 offset:1536
    v_mfma_f32_16x16x32_bf16 v[48:51], v[164:167], v[72:75], v[48:51]
    ds_read_b128 v[100:103], v13 offset:2752
    s_waitcnt lgkmcnt(6)
    v_mfma_f32_16x16x32_bf16 v[44:47], v[152:155], v[76:79], v[44:47]
    ds_read_b128 v[104:107], v13 offset:2688
    v_mfma_f32_16x16x32_bf16 v[48:51], v[168:171], v[76:79], v[48:51]
    ds_read_b128 v[108:111], v13 offset:2624
    s_waitcnt lgkmcnt(7)
    v_mfma_f32_16x16x32_bf16 v[44:47], v[156:159], v[80:83], v[44:47]
    ds_read_b128 v[112:115], v13 offset:2560
    v_mfma_f32_16x16x32_bf16 v[48:51], v[172:175], v[80:83], v[48:51]
    ds_read_b128 v[68:71], v13 offset:3264
    s_waitcnt lgkmcnt(8)
    v_mfma_f32_16x16x32_bf16 v[44:47], v[160:163], v[84:87], v[44:47]
    ds_read_b128 v[72:75], v13 offset:3200
    s_waitcnt lgkmcnt(8)
    v_mfma_f32_16x16x32_bf16 v[44:47], v[164:167], v[88:91], v[44:47]
    ds_read_b128 v[76:79], v13 offset:3136
    s_waitcnt lgkmcnt(8)
    v_mfma_f32_16x16x32_bf16 v[44:47], v[168:171], v[92:95], v[44:47]
    ds_read_b128 v[80:83], v13 offset:3072
    s_waitcnt lgkmcnt(8)
    v_mfma_f32_16x16x32_bf16 v[44:47], v[172:175], v[96:99], v[44:47]
    ds_read_b64 v[196:197], v12 offset:2112
    v_mfma_f32_16x16x32_bf16 v[48:51], v[188:191], v[96:99], v[48:51]
    ds_read_b128 v[96:99], v13 offset:1216
    v_mfma_f32_16x16x32_bf16 v[48:51], v[184:187], v[92:95], v[48:51]
    ds_read_b128 v[92:95], v13 offset:1152
    v_mfma_f32_16x16x32_bf16 v[48:51], v[180:183], v[88:91], v[48:51]
    ds_read_b128 v[88:91], v13 offset:1088
    v_mfma_f32_16x16x32_bf16 v[48:51], v[176:179], v[84:87], v[48:51]
    ds_read_b128 v[84:87], v13 offset:1024
    s_waitcnt lgkmcnt(8)
    v_mfma_f32_16x16x32_bf16 v[44:47], v[128:131], v[100:103], v[44:47]
    ds_read_b64 v[198:199], v12 offset:2120
    v_mfma_f32_16x16x32_bf16 v[44:47], v[132:135], v[104:107], v[44:47]
    ds_read_b64 v[200:201], v12 offset:2176
    v_mfma_f32_16x16x32_bf16 v[44:47], v[136:139], v[108:111], v[44:47]
    ds_read_b64 v[202:203], v12 offset:2184
    v_mfma_f32_16x16x32_bf16 v[44:47], v[140:143], v[112:115], v[44:47]
    ds_read_b64 v[204:205], v12 offset:2240
    v_mfma_f32_16x16x32_bf16 v[48:51], v[156:159], v[112:115], v[48:51]
    ds_read_b64 v[206:207], v12 offset:2248
    v_mfma_f32_16x16x32_bf16 v[48:51], v[152:155], v[108:111], v[48:51]
    ds_read_b128 v[112:115], v13 offset:704
    v_mfma_f32_16x16x32_bf16 v[48:51], v[148:151], v[104:107], v[48:51]
    ds_read_b128 v[108:111], v13 offset:640
    v_mfma_f32_16x16x32_bf16 v[48:51], v[144:147], v[100:103], v[48:51]
    ds_read_b128 v[104:107], v13 offset:576
    v_mfma_f32_16x16x32_bf16 v[48:51], v[128:131], v[68:71], v[48:51]
    ds_read_b128 v[100:103], v13 offset:512
    s_waitcnt lgkmcnt(8)
    v_mfma_f32_16x16x32_bf16 v[48:51], v[132:135], v[72:75], v[48:51]
    ds_read_b64 v[220:221], v12 offset:2752
    v_mfma_f32_16x16x32_bf16 v[48:51], v[136:139], v[76:79], v[48:51]
    ds_read_b64 v[222:223], v12 offset:2760
    v_mfma_f32_16x16x32_bf16 v[48:51], v[140:143], v[80:83], v[48:51]
    ds_read_b64 v[216:217], v12 offset:2688
    v_mfma_f32_16x16x32_bf16 v[40:43], v[128:131], v[96:99], 0
    ds_read_b64 v[218:219], v12 offset:2696
    v_mfma_f32_16x16x32_bf16 v[40:43], v[132:135], v[92:95], v[40:43]
    ds_read_b64 v[212:213], v12 offset:2624
    v_mfma_f32_16x16x32_bf16 v[40:43], v[136:139], v[88:91], v[40:43]
    ds_read_b64 v[214:215], v12 offset:2632
    v_mfma_f32_16x16x32_bf16 v[40:43], v[140:143], v[84:87], v[40:43]
    ds_read_b64 v[208:209], v12 offset:2560
    v_mfma_f32_16x16x32_bf16 v[44:47], v[188:191], v[84:87], v[44:47]
    ds_read_b64 v[210:211], v12 offset:2568
    v_mfma_f32_16x16x32_bf16 v[44:47], v[184:187], v[88:91], v[44:47]
    ds_read_b128 v[68:71], v13 offset:192
    v_mfma_f32_16x16x32_bf16 v[44:47], v[180:183], v[92:95], v[44:47]
    ds_read_b128 v[72:75], v13 offset:128
    v_mfma_f32_16x16x32_bf16 v[44:47], v[176:179], v[96:99], v[44:47]
    ds_read_b128 v[76:79], v13 offset:64
    v_mfma_f32_16x16x32_bf16 v[48:51], v[192:195], v[96:99], v[48:51]
    ds_read_b128 v[80:83], v13 offset:0
    v_mfma_f32_16x16x32_bf16 v[48:51], v[196:199], v[92:95], v[48:51]
    ds_read_b64 v[236:237], v12 offset:3264
    s_waitcnt lgkmcnt(8)
    v_mfma_f32_16x16x32_bf16 v[48:51], v[200:203], v[88:91], v[48:51]
    ds_read_b64 v[238:239], v12 offset:3272
    v_mfma_f32_16x16x32_bf16 v[48:51], v[204:207], v[84:87], v[48:51]
    ds_read_b64 v[232:233], v12 offset:3200
    v_mfma_f32_16x16x32_bf16 v[36:39], v[128:131], v[112:115], 0
    ds_read_b64 v[234:235], v12 offset:3208
    v_mfma_f32_16x16x32_bf16 v[36:39], v[132:135], v[108:111], v[36:39]
    ds_read_b64 v[228:229], v12 offset:3136
    v_mfma_f32_16x16x32_bf16 v[36:39], v[136:139], v[104:107], v[36:39]
    ds_read_b64 v[230:231], v12 offset:3144
    v_mfma_f32_16x16x32_bf16 v[36:39], v[140:143], v[100:103], v[36:39]
    ds_read_b64 v[224:225], v12 offset:3072
    v_mfma_f32_16x16x32_bf16 v[40:43], v[156:159], v[100:103], v[40:43]
    ds_read_b64 v[226:227], v12 offset:3080
    v_mfma_f32_16x16x32_bf16 v[40:43], v[152:155], v[104:107], v[40:43]
    ds_read_b64 v[252:253], v12 offset:3776
    v_mfma_f32_16x16x32_bf16 v[40:43], v[148:151], v[108:111], v[40:43]
    ds_read_b64 v[254:255], v12 offset:3784
    v_mfma_f32_16x16x32_bf16 v[40:43], v[144:147], v[112:115], v[40:43]
    ds_read_b64 v[248:249], v12 offset:3712
    v_mfma_f32_16x16x32_bf16 v[44:47], v[192:195], v[112:115], v[44:47]
    ds_read_b64 v[250:251], v12 offset:3720
    v_mfma_f32_16x16x32_bf16 v[44:47], v[196:199], v[108:111], v[44:47]
    ds_read_b64 v[244:245], v12 offset:3648
    v_mfma_f32_16x16x32_bf16 v[44:47], v[200:203], v[104:107], v[44:47]
    ds_read_b64 v[246:247], v12 offset:3656
    v_mfma_f32_16x16x32_bf16 v[44:47], v[204:207], v[100:103], v[44:47]
    ds_read_b64 v[240:241], v12 offset:3584
    v_mfma_f32_16x16x32_bf16 v[48:51], v[220:223], v[100:103], v[48:51]
    ds_read_b64 v[242:243], v12 offset:3592
    v_mfma_f32_16x16x32_bf16 v[48:51], v[216:219], v[104:107], v[48:51]
    ds_read_b128 v[96:99], v13 offset:1216
    s_waitcnt lgkmcnt(8)
    v_mfma_f32_16x16x32_bf16 v[48:51], v[212:215], v[108:111], v[48:51]
    ds_read_b128 v[92:95], v13 offset:1152
    v_mfma_f32_16x16x32_bf16 v[48:51], v[208:211], v[112:115], v[48:51]
    ds_read_b128 v[88:91], v13 offset:1088
    v_mfma_f32_16x16x32_bf16 v[36:39], v[144:147], v[68:71], v[36:39]
    ds_read_b128 v[84:87], v13 offset:1024
    v_mfma_f32_16x16x32_bf16 v[36:39], v[148:151], v[72:75], v[36:39]
    v_mfma_f32_16x16x32_bf16 v[36:39], v[152:155], v[76:79], v[36:39]
    v_mfma_f32_16x16x32_bf16 v[36:39], v[156:159], v[80:83], v[36:39]
    v_mfma_f32_16x16x32_bf16 v[40:43], v[172:175], v[80:83], v[40:43]
    v_mfma_f32_16x16x32_bf16 v[40:43], v[168:171], v[76:79], v[40:43]
    v_mfma_f32_16x16x32_bf16 v[40:43], v[164:167], v[72:75], v[40:43]
    v_mfma_f32_16x16x32_bf16 v[40:43], v[160:163], v[68:71], v[40:43]
    v_mfma_f32_16x16x32_bf16 v[44:47], v[208:211], v[68:71], v[44:47]
    v_mfma_f32_16x16x32_bf16 v[44:47], v[212:215], v[72:75], v[44:47]
    v_mfma_f32_16x16x32_bf16 v[44:47], v[216:219], v[76:79], v[44:47]
    v_mfma_f32_16x16x32_bf16 v[44:47], v[220:223], v[80:83], v[44:47]
    ds_write_b128 v8, v[36:39] offset:0
    v_mfma_f32_16x16x32_bf16 v[48:51], v[236:239], v[80:83], v[48:51]
    v_mfma_f32_16x16x32_bf16 v[48:51], v[232:235], v[76:79], v[48:51]
    v_mfma_f32_16x16x32_bf16 v[48:51], v[228:231], v[72:75], v[48:51]
    v_mfma_f32_16x16x32_bf16 v[48:51], v[224:227], v[68:71], v[48:51]
    ds_write_b128 v8, v[40:43] offset:1024
    v_mfma_f32_16x16x32_bf16 v[52:55], v[128:131], v[68:71], 0
    v_mfma_f32_16x16x32_bf16 v[52:55], v[132:135], v[72:75], v[52:55]
    v_mfma_f32_16x16x32_bf16 v[52:55], v[136:139], v[76:79], v[52:55]
    v_mfma_f32_16x16x32_bf16 v[52:55], v[140:143], v[80:83], v[52:55]
    ds_write_b128 v8, v[44:47] offset:2048
    v_mfma_f32_16x16x32_bf16 v[56:59], v[188:191], v[80:83], 0
    v_mfma_f32_16x16x32_bf16 v[56:59], v[184:187], v[76:79], v[56:59]
    v_mfma_f32_16x16x32_bf16 v[56:59], v[180:183], v[72:75], v[56:59]
    v_mfma_f32_16x16x32_bf16 v[56:59], v[176:179], v[68:71], v[56:59]
    ds_write_b128 v8, v[48:51] offset:3072
    v_mfma_f32_16x16x32_bf16 v[60:63], v[192:195], v[68:71], 0
    ds_write_b32 v10, v35
    v_mfma_f32_16x16x32_bf16 v[60:63], v[196:199], v[72:75], v[60:63]
    v_mfma_f32_16x16x32_bf16 v[60:63], v[200:203], v[76:79], v[60:63]
    v_mfma_f32_16x16x32_bf16 v[60:63], v[204:207], v[80:83], v[60:63]
    s_waitcnt lgkmcnt(2)
    v_mfma_f32_16x16x32_bf16 v[64:67], v[252:255], v[80:83], 0
    ds_read_b128 v[80:83], v13 offset:1728
    v_mfma_f32_16x16x32_bf16 v[64:67], v[248:251], v[76:79], v[64:67]
    ds_read_b128 v[76:79], v13 offset:1664
    v_mfma_f32_16x16x32_bf16 v[64:67], v[244:247], v[72:75], v[64:67]
    ds_read_b128 v[72:75], v13 offset:1600
    v_mfma_f32_16x16x32_bf16 v[64:67], v[240:243], v[68:71], v[64:67]
    ds_read_b128 v[244:247], v13 offset:1536
    v_mfma_f32_16x16x32_bf16 v[56:59], v[160:163], v[112:115], v[56:59]
    ds_read_b128 v[68:71], v13 offset:2240
    v_mfma_f32_16x16x32_bf16 v[56:59], v[164:167], v[108:111], v[56:59]
    ds_read_b128 v[240:243], v13 offset:2176
    v_mfma_f32_16x16x32_bf16 v[56:59], v[168:171], v[104:107], v[56:59]
    ds_read_b32 v34, v4
    v_mfma_f32_16x16x32_bf16 v[56:59], v[172:175], v[100:103], v[56:59]
    ds_read_b128 v[36:39], v6 offset:0
    v_mfma_f32_16x16x32_bf16 v[60:63], v[188:191], v[100:103], v[60:63]
    ds_read_b128 v[40:43], v6 offset:1024
    v_mfma_f32_16x16x32_bf16 v[60:63], v[184:187], v[104:107], v[60:63]
    ds_read_b128 v[44:47], v6 offset:2048
    v_mfma_f32_16x16x32_bf16 v[60:63], v[180:183], v[108:111], v[60:63]
    ds_read_b128 v[48:51], v6 offset:3072
    v_mfma_f32_16x16x32_bf16 v[60:63], v[176:179], v[112:115], v[60:63]
    v_mfma_f32_16x16x32_bf16 v[64:67], v[224:227], v[112:115], v[64:67]
    ds_read_b128 v[112:115], v13 offset:2112
    v_mfma_f32_16x16x32_bf16 v[64:67], v[228:231], v[108:111], v[64:67]
    ds_read_b128 v[224:227], v13 offset:2048
    v_mfma_f32_16x16x32_bf16 v[64:67], v[232:235], v[104:107], v[64:67]
    ds_read_b128 v[108:111], v13 offset:2752
    v_mfma_f32_16x16x32_bf16 v[64:67], v[236:239], v[100:103], v[64:67]
    ds_read_b128 v[228:231], v13 offset:2688
    v_mfma_f32_16x16x32_bf16 v[56:59], v[144:147], v[96:99], v[56:59]
    ds_read_b128 v[104:107], v13 offset:2624
    v_mfma_f32_16x16x32_bf16 v[56:59], v[148:151], v[92:95], v[56:59]
    ds_read_b128 v[232:235], v13 offset:2560
    v_mfma_f32_16x16x32_bf16 v[56:59], v[152:155], v[88:91], v[56:59]
    ds_read_b128 v[100:103], v13 offset:3264
    v_mfma_f32_16x16x32_bf16 v[56:59], v[156:159], v[84:87], v[56:59]
    s_waitcnt lgkmcnt(7)
    v_cmp_ne_u32 vcc, 1, v34
    s_cbranch_vccnz L_pxretryA
L_pxokA:
    v_mfma_f32_16x16x32_bf16 v[60:63], v[172:175], v[84:87], v[60:63]
    v_add_f32 v36, v36, v52
    v_add_f32 v37, v37, v53
    v_mfma_f32_16x16x32_bf16 v[60:63], v[168:171], v[88:91], v[60:63]
    v_add_f32 v38, v38, v54
    v_add_f32 v39, v39, v55
    v_mfma_f32_16x16x32_bf16 v[60:63], v[164:167], v[92:95], v[60:63]
    v_cvt_pk_bf16_f32 v36, v36, v37
    v_cvt_pk_bf16_f32 v37, v38, v39
    v_mfma_f32_16x16x32_bf16 v[60:63], v[160:163], v[96:99], v[60:63]
    global_store_dwordx2 v120, v[36:37], s[38:39]
    v_mfma_f32_16x16x32_bf16 v[64:67], v[208:211], v[96:99], v[64:67]
    ds_read_b128 v[236:239], v13 offset:3200
    v_mfma_f32_16x16x32_bf16 v[64:67], v[212:215], v[92:95], v[64:67]
    ds_read_b128 v[96:99], v13 offset:3136
    v_mfma_f32_16x16x32_bf16 v[64:67], v[216:219], v[88:91], v[64:67]
    ds_read_b128 v[208:211], v13 offset:3072
    v_mfma_f32_16x16x32_bf16 v[64:67], v[220:223], v[84:87], v[64:67]
    ds_read_b128 v[92:95], v13 offset:3776
    v_mfma_f32_16x16x32_bf16 v[56:59], v[128:131], v[80:83], v[56:59]
    global_load_dword v14, v11, s[46:47] offset:1024 sc1
    v_mfma_f32_16x16x32_bf16 v[56:59], v[132:135], v[76:79], v[56:59]
    ds_read_b128 v[212:215], v13 offset:3712
    v_mfma_f32_16x16x32_bf16 v[56:59], v[136:139], v[72:75], v[56:59]
    ds_read_b128 v[88:91], v13 offset:3648
    v_mfma_f32_16x16x32_bf16 v[56:59], v[140:143], v[244:247], v[56:59]
    ds_read_b128 v[216:219], v13 offset:3584
    v_mfma_f32_16x16x32_bf16 v[60:63], v[156:159], v[244:247], v[60:63]
    v_mfma_f32_16x16x32_bf16 v[60:63], v[152:155], v[72:75], v[60:63]
    v_mfma_f32_16x16x32_bf16 v[60:63], v[148:151], v[76:79], v[60:63]
    v_mfma_f32_16x16x32_bf16 v[60:63], v[144:147], v[80:83], v[60:63]
    v_mfma_f32_16x16x32_bf16 v[60:63], v[128:131], v[68:71], v[60:63]
    v_mfma_f32_16x16x32_bf16 v[60:63], v[132:135], v[240:243], v[60:63]
    s_waitcnt lgkmcnt(2)
    v_mfma_f32_16x16x32_bf16 v[60:63], v[136:139], v[112:115], v[60:63]
    v_mfma_f32_16x16x32_bf16 v[60:63], v[140:143], v[224:227], v[60:63]
    v_add_f32 v40, v40, v56
    v_add_f32 v41, v41, v57
    v_mfma_f32_16x16x32_bf16 v[64:67], v[192:195], v[80:83], v[64:67]
    v_add_f32 v42, v42, v58
    v_add_f32 v43, v43, v59
    v_mfma_f32_16x16x32_bf16 v[64:67], v[196:199], v[76:79], v[64:67]
    v_cvt_pk_bf16_f32 v40, v40, v41
    v_cvt_pk_bf16_f32 v41, v42, v43
    v_mfma_f32_16x16x32_bf16 v[64:67], v[200:203], v[72:75], v[64:67]
    global_store_dwordx2 v121, v[40:41], s[38:39]
    v_mfma_f32_16x16x32_bf16 v[64:67], v[204:207], v[244:247], v[64:67]
    v_mfma_f32_16x16x32_bf16 v[64:67], v[176:179], v[68:71], v[64:67]
    v_mfma_f32_16x16x32_bf16 v[64:67], v[180:183], v[240:243], v[64:67]
    v_mfma_f32_16x16x32_bf16 v[64:67], v[184:187], v[112:115], v[64:67]
    v_mfma_f32_16x16x32_bf16 v[64:67], v[188:191], v[224:227], v[64:67]
    v_add_f32 v44, v44, v60
    v_add_f32 v45, v45, v61
    v_mfma_f32_16x16x32_bf16 v[64:67], v[160:163], v[108:111], v[64:67]
    v_add_f32 v46, v46, v62
    v_add_f32 v47, v47, v63
    v_mfma_f32_16x16x32_bf16 v[64:67], v[164:167], v[228:231], v[64:67]
    v_cvt_pk_bf16_f32 v44, v44, v45
    v_cvt_pk_bf16_f32 v45, v46, v47
    v_mfma_f32_16x16x32_bf16 v[64:67], v[168:171], v[104:107], v[64:67]
    global_store_dwordx2 v122, v[44:45], s[38:39]
    v_mfma_f32_16x16x32_bf16 v[64:67], v[172:175], v[232:235], v[64:67]
    v_mfma_f32_16x16x32_bf16 v[64:67], v[144:147], v[100:103], v[64:67]
    v_mfma_f32_16x16x32_bf16 v[64:67], v[148:151], v[236:239], v[64:67]
    v_mfma_f32_16x16x32_bf16 v[64:67], v[152:155], v[96:99], v[64:67]
    v_mfma_f32_16x16x32_bf16 v[64:67], v[156:159], v[208:211], v[64:67]
    v_mfma_f32_16x16x32_bf16 v[64:67], v[128:131], v[92:95], v[64:67]
    v_mfma_f32_16x16x32_bf16 v[64:67], v[132:135], v[212:215], v[64:67]
    s_waitcnt lgkmcnt(0)
    v_mfma_f32_16x16x32_bf16 v[64:67], v[136:139], v[88:91], v[64:67]
    v_mfma_f32_16x16x32_bf16 v[64:67], v[140:143], v[216:219], v[64:67]
    ds_read_b32 v28, v26
    ds_read2_b32 v[248:249], v25 offset0:0 offset1:32
    ds_read2_b32 v[250:251], v25 offset0:64 offset1:96
    ds_read2_b32 v[252:253], v25 offset0:128 offset1:160
    ds_read2_b32 v[254:255], v25 offset0:192 offset1:224
    s_nop 2
    v_add_f32 v48, v48, v64
    v_add_f32 v49, v49, v65
    v_add_f32 v50, v50, v66
    v_add_f32 v51, v51, v67
    v_cvt_pk_bf16_f32 v64, v48, v49
    v_cvt_pk_bf16_f32 v66, v48, v49
    v_cvt_pk_bf16_f32 v65, v50, v51
    v_cvt_pk_bf16_f32 v67, v50, v51
    v_permlane16_swap_b32 v64, v66
    s_nop 0
    v_permlane16_swap_b32 v65, v67
    s_mov_b64 exec, s[56:57]
    global_store_dwordx4 v123, v[64:67], s[38:39]
    s_mov_b64 exec, -1
    s_cmp_lg_u32 s53, 0
    s_cbranch_scc1 L_yslowA
L_ybackA:
    s_waitcnt vmcnt(3)
    v_cmp_ne_u32 vcc, s29, v14
    s_cbranch_vccnz L_clrretryA
L_clrokA:
    s_waitcnt lgkmcnt(0)
    v_cmp_ne_u32 vcc, 1, v28
    s_cbranch_vccnz L_qretryA
L_qokA:
    v_lshlrev_b32 v128, 16, v248
    v_and_b32 v129, 0xffff0000, v248
    v_lshlrev_b32 v130, 16, v249
    v_and_b32 v131, 0xffff0000, v249
    v_lshlrev_b32 v132, 16, v250
    v_and_b32 v133, 0xffff0000, v250
    v_lshlrev_b32 v134, 16, v251
    v_and_b32 v135, 0xffff0000, v251
    v_lshlrev_b32 v136, 16, v252
    v_and_b32 v137, 0xffff0000, v252
    v_lshlrev_b32 v138, 16, v253
    v_and_b32 v139, 0xffff0000, v253
    v_lshlrev_b32 v140, 16, v254
    v_and_b32 v141, 0xffff0000, v254
    v_lshlrev_b32 v142, 16, v255
    v_and_b32 v143, 0xffff0000, v255
    v_pk_mul_f32 v[144:145], v[16:17], v[128:129]
    v_pk_mul_f32 v[146:147], v[18:19], v[130:131]
    v_pk_mul_f32 v[148:149], v[20:21], v[132:133]
    v_pk_mul_f32 v[150:151], v[22:23], v[134:135]
    v_pk_mul_f32 v[152:153], v[116:117], v[136:137]
    v_pk_mul_f32 v[154:155], v[118:119], v[138:139]
    v_pk_mul_f32 v[156:157], v[124:125], v[140:141]
    v_pk_mul_f32 v[158:159], v[126:127], v[142:143]
    global_load_dwordx4 v[72:75], v9, s[36:37] sc1
    global_load_dwordx4 v[76:79], v29, s[36:37] sc1
L_ypollA:
    s_waitcnt vmcnt(0)
    v_cmpx_ne_u32 vcc, s59, v72
    v_cmpx_ne_u32 vcc, s59, v73
    v_cmpx_ne_u32 vcc, s59, v74
    v_cmpx_ne_u32 vcc, s59, v75
    v_cmpx_ne_u32 vcc, s59, v76
    v_cmpx_ne_u32 vcc, s59, v77
    v_cmpx_ne_u32 vcc, s59, v78
    v_cmpx_ne_u32 vcc, s59, v79
    s_nop 0
    s_not_b64 exec, vcc
    s_cbranch_scc0 L_yokA
    global_load_dwordx4 v[72:75], v9, s[36:37] sc1
    global_load_dwordx4 v[76:79], v29, s[36:37] sc1
    s_mov_b64 exec, -1
    s_add_u32 s58, s58, 1
    s_cmp_gt_u32 s58, 0x1000000
    s_cbranch_scc1 L_exit
    s_branch L_ypollA
L_yokA:
    s_mov_b64 exec, -1
    s_nop 0
    v_permlane16_swap_b32 v72, v76
    v_permlane16_swap_b32 v73, v77
    v_permlane16_swap_b32 v74, v78
    v_permlane16_swap_b32 v75, v79
    v_lshlrev_b32 v80, 16, v72
    v_and_b32 v82, 0xffff0000, v72
    v_lshlrev_b32 v81, 16, v76
    v_and_b32 v83, 0xffff0000, v76
    v_pk_fma_f32 v[80:81], v[80:81], v[128:129], v[144:145]
    v_pk_fma_f32 v[82:83], v[82:83], v[130:131], v[146:147]
    v_cvt_pk_bf16_f32 v80, v80, v81
    v_cvt_pk_bf16_f32 v82, v82, v83
    global_store_dword v30, v80, s[20:21] offset:-4096 nt
    global_store_dword v30, v82, s[20:21] offset:-2048 nt
    v_lshlrev_b32 v84, 16, v73
    v_and_b32 v86, 0xffff0000, v73
    v_lshlrev_b32 v85, 16, v77
    v_and_b32 v87, 0xffff0000, v77
    v_pk_fma_f32 v[84:85], v[84:85], v[132:133], v[148:149]
    v_pk_fma_f32 v[86:87], v[86:87], v[134:135], v[150:151]
    v_cvt_pk_bf16_f32 v84, v84, v85
    v_cvt_pk_bf16_f32 v86, v86, v87
    global_store_dword v30, v84, s[20:21] offset:0 nt
    global_store_dword v30, v86, s[20:21] offset:2048 nt
    v_lshlrev_b32 v88, 16, v74
    v_and_b32 v90, 0xffff0000, v74
    v_lshlrev_b32 v89, 16, v78
    v_and_b32 v91, 0xffff0000, v78
    v_pk_fma_f32 v[88:89], v[88:89], v[136:137], v[152:153]
    v_pk_fma_f32 v[90:91], v[90:91], v[138:139], v[154:155]
    v_cvt_pk_bf16_f32 v88, v88, v89
    v_cvt_pk_bf16_f32 v90, v90, v91
    global_store_dword v31, v88, s[20:21] offset:-4096 nt
    global_store_dword v31, v90, s[20:21] offset:-2048 nt
    v_lshlrev_b32 v92, 16, v75
    v_and_b32 v94, 0xffff0000, v75
    v_lshlrev_b32 v93, 16, v79
    v_and_b32 v95, 0xffff0000, v79
    v_pk_fma_f32 v[92:93], v[92:93], v[140:141], v[156:157]
    v_pk_fma_f32 v[94:95], v[94:95], v[142:143], v[158:159]
    v_cvt_pk_bf16_f32 v92, v92, v93
    v_cvt_pk_bf16_f32 v94, v94, v95
    global_store_dword v31, v92, s[20:21] offset:0 nt
    global_store_dword v31, v94, s[20:21] offset:2048 nt
    s_endpgm
L_pxretryA:
    s_add_u32 s58, s58, 1
    s_cmp_gt_u32 s58, 0x1000000
    s_cbranch_scc1 L_exit
    ds_read_b32 v34, v4
    ds_read_b128 v[36:39], v6 offset:0
    ds_read_b128 v[40:43], v6 offset:1024
    ds_read_b128 v[44:47], v6 offset:2048
    ds_read_b128 v[48:51], v6 offset:3072
    s_waitcnt lgkmcnt(0)
    v_cmp_ne_u32 vcc, 1, v34
    s_cbranch_vccnz L_pxretryA
    s_branch L_pxokA
L_yslowA:
    global_store_dwordx2 v120, v[36:37], s[36:37] sc1
    global_store_dwordx2 v121, v[40:41], s[36:37] sc1
    global_store_dwordx2 v122, v[44:45], s[36:37] sc1
    s_mov_b64 exec, s[56:57]
    global_store_dwordx4 v123, v[64:67], s[36:37] sc1
    s_mov_b64 exec, -1
    s_waitcnt vmcnt(0)
    s_branch L_ybackA
L_clrretryA:
    s_add_u32 s58, s58, 1
    s_cmp_gt_u32 s58, 0x1000000
    s_cbranch_scc1 L_exit
    global_load_dword v14, v11, s[46:47] offset:1024 sc1
    s_waitcnt vmcnt(0)
    v_cmp_ne_u32 vcc, s29, v14
    s_cbranch_vccnz L_clrretryA
    s_branch L_clrokA
L_qretryA:
    s_add_u32 s58, s58, 1
    s_cmp_gt_u32 s58, 0x1000000
    s_cbranch_scc1 L_exit
    ds_read_b32 v28, v26
    ds_read2_b32 v[248:249], v25 offset0:0 offset1:32
    ds_read2_b32 v[250:251], v25 offset0:64 offset1:96
    ds_read2_b32 v[252:253], v25 offset0:128 offset1:160
    ds_read2_b32 v[254:255], v25 offset0:192 offset1:224
    s_waitcnt lgkmcnt(0)
    v_cmp_ne_u32 vcc, 1, v28
    s_cbranch_vccnz L_qretryA
    s_branch L_qokA
.p2align 12
L_sec_varB:
L_convB:
    s_lshl_b32 s42, s48, 5
    s_add_u32 s41, s51, s42
    v_lshl_add_u32 v27, v1, 15, s41
    v_lshl_add_u32 v27, v3, 3, v27
    v_add_u32 v120, 524288, v27
    v_add_u32 v121, 1048576, v27
    v_add_u32 v122, 2621440, v27
    v_add_u32 v123, 3145728, v27
    s_mul_i32 s54, s53, 1536
    s_lshr_b32 s40, s25, 3
    s_lshl_b32 s40, s40, 7
    s_add_u32 s40, s40, s54
    v_add_u32 v11, s40, v11
    s_mov_b32 s56, 0xffff
    s_mov_b32 s57, 0xffff
    s_barrier
    ds_read_b64 v[128:129], v12 offset:0
    ds_read_b64 v[130:131], v12 offset:8
    ds_read_b64 v[176:177], v12 offset:1536
    ds_read_b64 v[178:179], v12 offset:1544
    ds_read_b64 v[132:133], v12 offset:64
    ds_read_b64 v[134:135], v12 offset:72
    ds_read_b64 v[180:181], v12 offset:1600
    ds_read_b64 v[182:183], v12 offset:1608
    ds_read_b64 v[136:137], v12 offset:128
    ds_read_b64 v[138:139], v12 offset:136
    global_load_dwordx4 v[100:103], v14, s[36:37] sc1
    global_load_dwordx4 v[104:107], v15, s[36:37] sc1
    ds_read_b64 v[184:185], v12 offset:1664
    ds_read_b64 v[186:187], v12 offset:1672
    ds_read_b64 v[140:141], v12 offset:192
    ds_read_b64 v[142:143], v12 offset:200
    ds_read_b64 v[188:189], v12 offset:1728
    ds_read_b64 v[190:191], v12 offset:1736
    ds_read_b64 v[156:157], v12 offset:704
    ds_read_b64 v[158:159], v12 offset:712
    ds_read_b64 v[152:153], v12 offset:640
    ds_read_b64 v[154:155], v12 offset:648
    ds_read_b64 v[148:149], v12 offset:576
    ds_read_b64 v[150:151], v12 offset:584
    ds_read_b64 v[144:145], v12 offset:512
    ds_read_b64 v[146:147], v12 offset:520
    ds_read_b64 v[192:193], v12 offset:2048
    ds_read_b64 v[194:195], v12 offset:2056
    ds_read_b64 v[196:197], v12 offset:2112
    ds_read_b64 v[198:199], v12 offset:2120
    ds_read_b64 v[200:201], v12 offset:2176
    ds_read_b64 v[202:203], v12 offset:2184
    ds_read_b64 v[204:205], v12 offset:2240
    ds_read_b64 v[206:207], v12 offset:2248
    ds_read_b64 v[160:161], v12 offset:1024
    ds_read_b64 v[162:163], v12 offset:1032
    v_add_u32 v25, 59008, v25
L_xpollB:
    s_waitcnt vmcnt(0)
    ds_write_b128 v24, v[100:103] offset:33792
    ds_write_b128 v24, v[104:107] offset:34304
    v_cmpx_ne_u32 vcc, s59, v100
    v_cmpx_ne_u32 vcc, s59, v101
    v_cmpx_ne_u32 vcc, s59, v102
    v_cmpx_ne_u32 vcc, s59, v103
    v_cmpx_ne_u32 vcc, s59, v104
    v_cmpx_ne_u32 vcc, s59, v105
    v_cmpx_ne_u32 vcc, s59, v106
    v_cmpx_ne_u32 vcc, s59, v107
    s_nop 0
    s_not_b64 exec, vcc
    s_cbranch_scc0 L_xokB
    s_waitcnt lgkmcnt(0)
    global_load_dwordx4 v[100:103], v14, s[36:37] sc1
    global_load_dwordx4 v[104:107], v15, s[36:37] sc1
    s_mov_b64 exec, -1
    s_add_u32 s58, s58, 1
    s_cmp_gt_u32 s58, 0x1000000
    s_cbranch_scc1 L_exit
    s_branch L_xpollB
L_xokB:
    s_mov_b64 exec, -1
    s_waitcnt lgkmcnt(0)
    s_barrier
    ds_read_b128 v[68:71], v13 offset:2240
    ds_read_b128 v[72:75], v13 offset:2176
    ds_read_b128 v[76:79], v13 offset:2112
    ds_read_b128 v[80:83], v13 offset:2048
    ds_read_b128 v[84:87], v13 offset:1728
    s_waitcnt lgkmcnt(4)
    v_mfma_f32_16x16x32_bf16 v[44:47], v[128:131], v[68:71], 0
    ds_read_b128 v[88:91], v13 offset:1664
    v_mfma_f32_16x16x32_bf16 v[48:51], v[176:179], v[68:71], 0
    ds_read_b128 v[92:95], v13 offset:1600
    s_waitcnt lgkmcnt(5)
    v_mfma_f32_16x16x32_bf16 v[44:47], v[132:135], v[72:75], v[44:47]
    ds_read_b128 v[96:99], v13 offset:1536
    v_mfma_f32_16x16x32_bf16 v[48:51], v[180:183], v[72:75], v[48:51]
    ds_read_b128 v[100:103], v13 offset:2752
    s_waitcnt lgkmcnt(6)
    v_mfma_f32_16x16x32_bf16 v[44:47], v[136:139], v[76:79], v[44:47]
    ds_read_b128 v[104:107], v13 offset:2688
    v_mfma_f32_16x16x32_bf16 v[48:51], v[184:187], v[76:79], v[48:51]
    ds_read_b64 v[164:165], v12 offset:1088
    s_waitcnt lgkmcnt(7)
    v_mfma_f32_16x16x32_bf16 v[44:47], v[140:143], v[80:83], v[44:47]
    ds_read_b64 v[166:167], v12 offset:1096
    v_mfma_f32_16x16x32_bf16 v[48:51], v[188:191], v[80:83], v[48:51]
    ds_read_b128 v[108:111], v13 offset:2624
    s_waitcnt lgkmcnt(8)
    v_mfma_f32_16x16x32_bf16 v[40:43], v[128:131], v[84:87], 0
    ds_read_b64 v[168:169], v12 offset:1152
    s_waitcnt lgkmcnt(8)
    v_mfma_f32_16x16x32_bf16 v[40:43], v[132:135], v[88:91], v[40:43]
    ds_read_b64 v[170:171], v12 offset:1160
    s_waitcnt lgkmcnt(8)
    v_mfma_f32_16x16x32_bf16 v[40:43], v[136:139], v[92:95], v[40:43]
    ds_read_b128 v[112:115], v13 offset:2560
    s_waitcnt lgkmcnt(8)
    v_mfma_f32_16x16x32_bf16 v[40:43], v[140:143], v[96:99], v[40:43]
    ds_read_b64 v[172:173], v12 offset:1216
    v_mfma_f32_16x16x32_bf16 v[44:47], v[156:159], v[96:99], v[44:47]
    ds_read_b64 v[174:175], v12 offset:1224
    v_mfma_f32_16x16x32_bf16 v[44:47], v[152:155], v[92:95], v[44:47]
    ds_read_b128 v[68:71], v13 offset:3264
    v_mfma_f32_16x16x32_bf16 v[44:47], v[148:151], v[88:91], v[44:47]
    ds_read_b128 v[72:75], v13 offset:3200
    v_mfma_f32_16x16x32_bf16 v[44:47], v[144:147], v[84:87], v[44:47]
    ds_read_b128 v[76:79], v13 offset:3136
    v_mfma_f32_16x16x32_bf16 v[48:51], v[192:195], v[84:87], v[48:51]
    ds_read_b128 v[80:83], v13 offset:3072
    v_mfma_f32_16x16x32_bf16 v[48:51], v[196:199], v[88:91], v[48:51]
    ds_read_b128 v[84:87], v13 offset:3776
    v_mfma_f32_16x16x32_bf16 v[48:51], v[200:203], v[92:95], v[48:51]
    ds_read_b128 v[88:91], v13 offset:3712
    v_mfma_f32_16x16x32_bf16 v[48:51], v[204:207], v[96:99], v[48:51]
    ds_read_b128 v[92:95], v13 offset:3648
    s_waitcnt lgkmcnt(8)
    v_mfma_f32_16x16x32_bf16 v[48:51], v[160:163], v[100:103], v[48:51]
    ds_read_b128 v[96:99], v13 offset:3584
    v_mfma_f32_16x16x32_bf16 v[48:51], v[164:167], v[104:107], v[48:51]
    ds_read_b128 v[100:103], v13 offset:1216
    v_mfma_f32_16x16x32_bf16 v[48:51], v[168:171], v[108:111], v[48:51]
    ds_read_b128 v[104:107], v13 offset:1152
    s_waitcnt lgkmcnt(8)
    v_mfma_f32_16x16x32_bf16 v[48:51], v[172:175], v[112:115], v[48:51]
    ds_read_b128 v[108:111], v13 offset:1088
    v_mfma_f32_16x16x32_bf16 v[48:51], v[144:147], v[68:71], v[48:51]
    ds_read_b128 v[112:115], v13 offset:1024
    v_mfma_f32_16x16x32_bf16 v[48:51], v[148:151], v[72:75], v[48:51]
    ds_read_b64 v[208:209], v12 offset:2560
    s_waitcnt lgkmcnt(8)
    v_mfma_f32_16x16x32_bf16 v[48:51], v[152:155], v[76:79], v[48:51]
    ds_read_b64 v[210:211], v12 offset:2568
    v_mfma_f32_16x16x32_bf16 v[48:51], v[156:159], v[80:83], v[48:51]
    ds_read_b64 v[212:213], v12 offset:2624
    v_mfma_f32_16x16x32_bf16 v[48:51], v[128:131], v[84:87], v[48:51]
    ds_read_b64 v[214:215], v12 offset:2632
    s_waitcnt lgkmcnt(8)
    v_mfma_f32_16x16x32_bf16 v[48:51], v[132:135], v[88:91], v[48:51]
    ds_read_b64 v[216:217], v12 offset:2688
    v_mfma_f32_16x16x32_bf16 v[48:51], v[136:139], v[92:95], v[48:51]
    ds_read_b64 v[218:219], v12 offset:2696
    v_mfma_f32_16x16x32_bf16 v[48:51], v[140:143], v[96:99], v[48:51]
    ds_read_b64 v[220:221], v12 offset:2752
    s_waitcnt lgkmcnt(8)
    v_mfma_f32_16x16x32_bf16 v[40:43], v[144:147], v[100:103], v[40:43]
    ds_read_b64 v[222:223], v12 offset:2760
    v_mfma_f32_16x16x32_bf16 v[40:43], v[148:151], v[104:107], v[40:43]
    ds_read_b128 v[68:71], v13 offset:704
    v_mfma_f32_16x16x32_bf16 v[40:43], v[152:155], v[108:111], v[40:43]
    ds_read_b128 v[72:75], v13 offset:640
    s_waitcnt lgkmcnt(8)
    v_mfma_f32_16x16x32_bf16 v[40:43], v[156:159], v[112:115], v[40:43]
    ds_read_b128 v[76:79], v13 offset:576
    v_mfma_f32_16x16x32_bf16 v[44:47], v[172:175], v[112:115], v[44:47]
    ds_read_b128 v[80:83], v13 offset:512
    v_mfma_f32_16x16x32_bf16 v[44:47], v[168:171], v[108:111], v[44:47]
    ds_read_b64 v[224:225], v12 offset:3072
    v_mfma_f32_16x16x32_bf16 v[44:47], v[164:167], v[104:107], v[44:47]
    ds_read_b64 v[226:227], v12 offset:3080
    v_mfma_f32_16x16x32_bf16 v[44:47], v[160:163], v[100:103], v[44:47]
    ds_read_b64 v[228:229], v12 offset:3136
    v_mfma_f32_16x16x32_bf16 v[48:51], v[208:211], v[100:103], v[48:51]
    ds_read_b64 v[230:231], v12 offset:3144
    s_waitcnt lgkmcnt(8)
    v_mfma_f32_16x16x32_bf16 v[48:51], v[212:215], v[104:107], v[48:51]
    ds_read_b64 v[232:233], v12 offset:3200
    v_mfma_f32_16x16x32_bf16 v[48:51], v[216:219], v[108:111], v[48:51]
    ds_read_b64 v[234:235], v12 offset:3208
    v_mfma_f32_16x16x32_bf16 v[48:51], v[220:223], v[112:115], v[48:51]
    ds_read_b64 v[236:237], v12 offset:3264
    s_waitcnt lgkmcnt(8)
    v_mfma_f32_16x16x32_bf16 v[40:43], v[160:163], v[68:71], v[40:43]
    ds_read_b64 v[238:239], v12 offset:3272
    v_mfma_f32_16x16x32_bf16 v[40:43], v[164:167], v[72:75], v[40:43]
    ds_read_b128 v[84:87], v13 offset:192
    v_mfma_f32_16x16x32_bf16 v[40:43], v[168:171], v[76:79], v[40:43]
    ds_read_b128 v[88:91], v13 offset:128
    s_waitcnt lgkmcnt(8)
    v_mfma_f32_16x16x32_bf16 v[40:43], v[172:175], v[80:83], v[40:43]
    ds_read_b128 v[92:95], v13 offset:64
    v_mfma_f32_16x16x32_bf16 v[44:47], v[188:191], v[80:83], v[44:47]
    ds_read_b128 v[96:99], v13 offset:0
    v_mfma_f32_16x16x32_bf16 v[44:47], v[184:187], v[76:79], v[44:47]
    ds_read_b64 v[252:253], v12 offset:3776
    v_mfma_f32_16x16x32_bf16 v[44:47], v[180:183], v[72:75], v[44:47]
    ds_read_b64 v[254:255], v12 offset:3784
    v_mfma_f32_16x16x32_bf16 v[44:47], v[176:179], v[68:71], v[44:47]
    ds_read_b64 v[248:249], v12 offset:3712
    v_mfma_f32_16x16x32_bf16 v[48:51], v[224:227], v[68:71], v[48:51]
    ds_read_b64 v[250:251], v12 offset:3720
    s_waitcnt lgkmcnt(8)
    v_mfma_f32_16x16x32_bf16 v[48:51], v[228:231], v[72:75], v[48:51]
    ds_read_b64 v[244:245], v12 offset:3648
    v_mfma_f32_16x16x32_bf16 v[48:51], v[232:235], v[76:79], v[48:51]
    ds_read_b64 v[246:247], v12 offset:3656
    v_mfma_f32_16x16x32_bf16 v[48:51], v[236:239], v[80:83], v[48:51]
    ds_read_b64 v[240:241], v12 offset:3584
    s_waitcnt lgkmcnt(8)
    v_mfma_f32_16x16x32_bf16 v[36:39], v[128:131], v[84:87], 0
    ds_read_b64 v[242:243], v12 offset:3592
    v_mfma_f32_16x16x32_bf16 v[36:39], v[132:135], v[88:91], v[36:39]
    ds_read_b128 v[100:103], v13 offset:1216
    v_mfma_f32_16x16x32_bf16 v[36:39], v[136:139], v[92:95], v[36:39]
    ds_read_b128 v[104:107], v13 offset:1152
    s_waitcnt lgkmcnt(8)
    v_mfma_f32_16x16x32_bf16 v[36:39], v[140:143], v[96:99], v[36:39]
    ds_read_b128 v[108:111], v13 offset:1088
    v_mfma_f32_16x16x32_bf16 v[40:43], v[188:191], v[96:99], v[40:43]
    ds_read_b128 v[112:115], v13 offset:1024
    v_mfma_f32_16x16x32_bf16 v[40:43], v[184:187], v[92:95], v[40:43]
    v_mfma_f32_16x16x32_bf16 v[40:43], v[180:183], v[88:91], v[40:43]
    v_mfma_f32_16x16x32_bf16 v[40:43], v[176:179], v[84:87], v[40:43]
    v_mfma_f32_16x16x32_bf16 v[44:47], v[192:195], v[84:87], v[44:47]
    v_mfma_f32_16x16x32_bf16 v[44:47], v[196:199], v[88:91], v[44:47]
    v_mfma_f32_16x16x32_bf16 v[44:47], v[200:203], v[92:95], v[44:47]
    v_mfma_f32_16x16x32_bf16 v[44:47], v[204:207], v[96:99], v[44:47]
    ds_write_b128 v8, v[36:39] offset:0
    v_mfma_f32_16x16x32_bf16 v[48:51], v[252:255], v[96:99], v[48:51]
    s_waitcnt lgkmcnt(1)
    v_mfma_f32_16x16x32_bf16 v[48:51], v[248:251], v[92:95], v[48:51]
    v_mfma_f32_16x16x32_bf16 v[48:51], v[244:247], v[88:91], v[48:51]
    ds_read_b128 v[244:247], v13 offset:1728
    v_mfma_f32_16x16x32_bf16 v[48:51], v[240:243], v[84:87], v[48:51]
    ds_write_b128 v8, v[40:43] offset:1024
    v_mfma_f32_16x16x32_bf16 v[52:55], v[144:147], v[84:87], 0
    ds_read_b128 v[240:243], v13 offset:1664
    v_mfma_f32_16x16x32_bf16 v[52:55], v[148:151], v[88:91], v[52:55]
    v_mfma_f32_16x16x32_bf16 v[52:55], v[152:155], v[92:95], v[52:55]
    v_mfma_f32_16x16x32_bf16 v[52:55], v[156:159], v[96:99], v[52:55]
    ds_write_b128 v8, v[44:47] offset:2048
    v_mfma_f32_16x16x32_bf16 v[56:59], v[172:175], v[96:99], 0
    v_mfma_f32_16x16x32_bf16 v[56:59], v[168:171], v[92:95], v[56:59]
    v_mfma_f32_16x16x32_bf16 v[56:59], v[164:167], v[88:91], v[56:59]
    v_mfma_f32_16x16x32_bf16 v[56:59], v[160:163], v[84:87], v[56:59]
    ds_write_b128 v8, v[48:51] offset:3072
    v_mfma_f32_16x16x32_bf16 v[60:63], v[208:211], v[84:87], 0
    ds_write_b32 v10, v35
    v_mfma_f32_16x16x32_bf16 v[60:63], v[212:215], v[88:91], v[60:63]
    v_mfma_f32_16x16x32_bf16 v[60:63], v[216:219], v[92:95], v[60:63]
    v_mfma_f32_16x16x32_bf16 v[60:63], v[220:223], v[96:99], v[60:63]
    v_mfma_f32_16x16x32_bf16 v[64:67], v[236:239], v[96:99], 0
    ds_read_b128 v[96:99], v13 offset:1600
    v_mfma_f32_16x16x32_bf16 v[64:67], v[232:235], v[92:95], v[64:67]
    ds_read_b128 v[236:239], v13 offset:1536
    v_mfma_f32_16x16x32_bf16 v[64:67], v[228:231], v[88:91], v[64:67]
    ds_read_b128 v[92:95], v13 offset:2240
    v_mfma_f32_16x16x32_bf16 v[64:67], v[224:227], v[84:87], v[64:67]
    ds_read_b128 v[232:235], v13 offset:2176
    v_mfma_f32_16x16x32_bf16 v[52:55], v[128:131], v[68:71], v[52:55]
    ds_read_b128 v[88:91], v13 offset:2112
    v_mfma_f32_16x16x32_bf16 v[52:55], v[132:135], v[72:75], v[52:55]
    ds_read_b128 v[228:231], v13 offset:2048
    v_mfma_f32_16x16x32_bf16 v[52:55], v[136:139], v[76:79], v[52:55]
    ds_read_b32 v34, v4
    v_mfma_f32_16x16x32_bf16 v[52:55], v[140:143], v[80:83], v[52:55]
    ds_read_b128 v[36:39], v6 offset:0
    v_mfma_f32_16x16x32_bf16 v[56:59], v[156:159], v[80:83], v[56:59]
    ds_read_b128 v[40:43], v6 offset:1024
    v_mfma_f32_16x16x32_bf16 v[56:59], v[152:155], v[76:79], v[56:59]
    ds_read_b128 v[44:47], v6 offset:2048
    v_mfma_f32_16x16x32_bf16 v[56:59], v[148:151], v[72:75], v[56:59]
    ds_read_b128 v[48:51], v6 offset:3072
    v_mfma_f32_16x16x32_bf16 v[56:59], v[144:147], v[68:71], v[56:59]
    ds_read_b128 v[84:87], v13 offset:2752
    v_mfma_f32_16x16x32_bf16 v[60:63], v[192:195], v[68:71], v[60:63]
    ds_read_b128 v[224:227], v13 offset:2688
    v_mfma_f32_16x16x32_bf16 v[60:63], v[196:199], v[72:75], v[60:63]
    v_mfma_f32_16x16x32_bf16 v[60:63], v[200:203], v[76:79], v[60:63]
    v_mfma_f32_16x16x32_bf16 v[60:63], v[204:207], v[80:83], v[60:63]
    v_mfma_f32_16x16x32_bf16 v[64:67], v[220:223], v[80:83], v[64:67]
    ds_read_b128 v[80:83], v13 offset:2624
    v_mfma_f32_16x16x32_bf16 v[64:67], v[216:219], v[76:79], v[64:67]
    ds_read_b128 v[220:223], v13 offset:2560
    v_mfma_f32_16x16x32_bf16 v[64:67], v[212:215], v[72:75], v[64:67]
    ds_read_b128 v[76:79], v13 offset:3264
    v_mfma_f32_16x16x32_bf16 v[64:67], v[208:211], v[68:71], v[64:67]
    s_waitcnt lgkmcnt(5)
    v_cmp_ne_u32 vcc, 1, v34
    s_cbranch_vccnz L_pxretryB
L_pxokB:
    v_mfma_f32_16x16x32_bf16 v[56:59], v[128:131], v[100:103], v[56:59]
    v_add_f32 v36, v36, v52
    v_add_f32 v37, v37, v53
    v_mfma_f32_16x16x32_bf16 v[56:59], v[132:135], v[104:107], v[56:59]
    v_add_f32 v38, v38, v54
    v_add_f32 v39, v39, v55
    v_mfma_f32_16x16x32_bf16 v[56:59], v[136:139], v[108:111], v[56:59]
    v_cvt_pk_bf16_f32 v36, v36, v37
    v_cvt_pk_bf16_f32 v37, v38, v39
    v_mfma_f32_16x16x32_bf16 v[56:59], v[140:143], v[112:115], v[56:59]
    global_store_dwordx2 v120, v[36:37], s[38:39]
    v_mfma_f32_16x16x32_bf16 v[60:63], v[188:191], v[112:115], v[60:63]
    ds_read_b128 v[216:219], v13 offset:3200
    v_mfma_f32_16x16x32_bf16 v[60:63], v[184:187], v[108:111], v[60:63]
    ds_read_b128 v[72:75], v13 offset:3136
    v_mfma_f32_16x16x32_bf16 v[60:63], v[180:183], v[104:107], v[60:63]
    ds_read_b128 v[212:215], v13 offset:3072
    v_mfma_f32_16x16x32_bf16 v[60:63], v[176:179], v[100:103], v[60:63]
    v_mfma_f32_16x16x32_bf16 v[60:63], v[160:163], v[244:247], v[60:63]
    global_load_dword v14, v11, s[46:47] offset:1024 sc1
    v_mfma_f32_16x16x32_bf16 v[60:63], v[164:167], v[240:243], v[60:63]
    v_mfma_f32_16x16x32_bf16 v[60:63], v[168:171], v[96:99], v[60:63]
    v_mfma_f32_16x16x32_bf16 v[60:63], v[172:175], v[236:239], v[60:63]
    v_add_f32 v40, v40, v56
    v_add_f32 v41, v41, v57
    v_mfma_f32_16x16x32_bf16 v[60:63], v[144:147], v[92:95], v[60:63]
    v_add_f32 v42, v42, v58
    v_add_f32 v43, v43, v59
    v_mfma_f32_16x16x32_bf16 v[60:63], v[148:151], v[232:235], v[60:63]
    v_cvt_pk_bf16_f32 v40, v40, v41
    v_cvt_pk_bf16_f32 v41, v42, v43
    v_mfma_f32_16x16x32_bf16 v[60:63], v[152:155], v[88:91], v[60:63]
    global_store_dwordx2 v121, v[40:41], s[38:39]
    v_mfma_f32_16x16x32_bf16 v[60:63], v[156:159], v[228:231], v[60:63]
    s_waitcnt lgkmcnt(0)
    v_mfma_f32_16x16x32_bf16 v[60:63], v[128:131], v[84:87], v[60:63]
    v_mfma_f32_16x16x32_bf16 v[60:63], v[132:135], v[224:227], v[60:63]
    v_mfma_f32_16x16x32_bf16 v[60:63], v[136:139], v[80:83], v[60:63]
    v_mfma_f32_16x16x32_bf16 v[60:63], v[140:143], v[220:223], v[60:63]
    v_mfma_f32_16x16x32_bf16 v[64:67], v[192:195], v[100:103], v[64:67]
    v_mfma_f32_16x16x32_bf16 v[64:67], v[196:199], v[104:107], v[64:67]
    v_mfma_f32_16x16x32_bf16 v[64:67], v[200:203], v[108:111], v[64:67]
    v_mfma_f32_16x16x32_bf16 v[64:67], v[204:207], v[112:115], v[64:67]
    v_mfma_f32_16x16x32_bf16 v[64:67], v[176:179], v[244:247], v[64:67]
    v_mfma_f32_16x16x32_bf16 v[64:67], v[180:183], v[240:243], v[64:67]
    v_mfma_f32_16x16x32_bf16 v[64:67], v[184:187], v[96:99], v[64:67]
    v_mfma_f32_16x16x32_bf16 v[64:67], v[188:191], v[236:239], v[64:67]
    v_add_f32 v44, v44, v60
    v_add_f32 v45, v45, v61
    v_mfma_f32_16x16x32_bf16 v[64:67], v[160:163], v[92:95], v[64:67]
    v_add_f32 v46, v46, v62
    v_add_f32 v47, v47, v63
    v_mfma_f32_16x16x32_bf16 v[64:67], v[164:167], v[232:235], v[64:67]
    v_cvt_pk_bf16_f32 v44, v44, v45
    v_cvt_pk_bf16_f32 v45, v46, v47
    v_mfma_f32_16x16x32_bf16 v[64:67], v[168:171], v[88:91], v[64:67]
    global_store_dwordx2 v122, v[44:45], s[38:39]
    v_mfma_f32_16x16x32_bf16 v[64:67], v[172:175], v[228:231], v[64:67]
    v_mfma_f32_16x16x32_bf16 v[64:67], v[144:147], v[84:87], v[64:67]
    v_mfma_f32_16x16x32_bf16 v[64:67], v[148:151], v[224:227], v[64:67]
    v_mfma_f32_16x16x32_bf16 v[64:67], v[152:155], v[80:83], v[64:67]
    v_mfma_f32_16x16x32_bf16 v[64:67], v[156:159], v[220:223], v[64:67]
    v_mfma_f32_16x16x32_bf16 v[64:67], v[128:131], v[76:79], v[64:67]
    v_mfma_f32_16x16x32_bf16 v[64:67], v[132:135], v[216:219], v[64:67]
    v_mfma_f32_16x16x32_bf16 v[64:67], v[136:139], v[72:75], v[64:67]
    v_mfma_f32_16x16x32_bf16 v[64:67], v[140:143], v[212:215], v[64:67]
    ds_read_b32 v28, v26
    ds_read2_b32 v[248:249], v25 offset0:0 offset1:32
    ds_read2_b32 v[250:251], v25 offset0:64 offset1:96
    ds_read2_b32 v[252:253], v25 offset0:128 offset1:160
    ds_read2_b32 v[254:255], v25 offset0:192 offset1:224
    s_nop 2
    v_add_f32 v48, v48, v64
    v_add_f32 v49, v49, v65
    v_add_f32 v50, v50, v66
    v_add_f32 v51, v51, v67
    v_cvt_pk_bf16_f32 v64, v48, v49
    v_cvt_pk_bf16_f32 v66, v48, v49
    v_cvt_pk_bf16_f32 v65, v50, v51
    v_cvt_pk_bf16_f32 v67, v50, v51
    v_permlane16_swap_b32 v64, v66
    s_nop 0
    v_permlane16_swap_b32 v65, v67
    s_mov_b64 exec, s[56:57]
    global_store_dwordx4 v123, v[64:67], s[38:39]
    s_mov_b64 exec, -1
    s_cmp_lg_u32 s53, 0
    s_cbranch_scc1 L_yslowB
L_ybackB:
    s_waitcnt vmcnt(3)
    v_cmp_ne_u32 vcc, s29, v14
    s_cbranch_vccnz L_clrretryB
L_clrokB:
    s_waitcnt lgkmcnt(0)
    v_cmp_ne_u32 vcc, 1, v28
    s_cbranch_vccnz L_qretryB
L_qokB:
    v_lshlrev_b32 v128, 16, v248
    v_and_b32 v129, 0xffff0000, v248
    v_lshlrev_b32 v130, 16, v249
    v_and_b32 v131, 0xffff0000, v249
    v_lshlrev_b32 v132, 16, v250
    v_and_b32 v133, 0xffff0000, v250
    v_lshlrev_b32 v134, 16, v251
    v_and_b32 v135, 0xffff0000, v251
    v_lshlrev_b32 v136, 16, v252
    v_and_b32 v137, 0xffff0000, v252
    v_lshlrev_b32 v138, 16, v253
    v_and_b32 v139, 0xffff0000, v253
    v_lshlrev_b32 v140, 16, v254
    v_and_b32 v141, 0xffff0000, v254
    v_lshlrev_b32 v142, 16, v255
    v_and_b32 v143, 0xffff0000, v255
    v_pk_mul_f32 v[144:145], v[16:17], v[128:129]
    v_pk_mul_f32 v[146:147], v[18:19], v[130:131]
    v_pk_mul_f32 v[148:149], v[20:21], v[132:133]
    v_pk_mul_f32 v[150:151], v[22:23], v[134:135]
    v_pk_mul_f32 v[152:153], v[116:117], v[136:137]
    v_pk_mul_f32 v[154:155], v[118:119], v[138:139]
    v_pk_mul_f32 v[156:157], v[124:125], v[140:141]
    v_pk_mul_f32 v[158:159], v[126:127], v[142:143]
    global_load_dwordx4 v[72:75], v9, s[36:37] sc1
    global_load_dwordx4 v[76:79], v29, s[36:37] sc1
L_ypollB:
    s_waitcnt vmcnt(0)
    v_cmpx_ne_u32 vcc, s59, v72
    v_cmpx_ne_u32 vcc, s59, v73
    v_cmpx_ne_u32 vcc, s59, v74
    v_cmpx_ne_u32 vcc, s59, v75
    v_cmpx_ne_u32 vcc, s59, v76
    v_cmpx_ne_u32 vcc, s59, v77
    v_cmpx_ne_u32 vcc, s59, v78
    v_cmpx_ne_u32 vcc, s59, v79
    s_nop 0
    s_not_b64 exec, vcc
    s_cbranch_scc0 L_yokB
    global_load_dwordx4 v[72:75], v9, s[36:37] sc1
    global_load_dwordx4 v[76:79], v29, s[36:37] sc1
    s_mov_b64 exec, -1
    s_add_u32 s58, s58, 1
    s_cmp_gt_u32 s58, 0x1000000
    s_cbranch_scc1 L_exit
    s_branch L_ypollB
L_yokB:
    s_mov_b64 exec, -1
    s_nop 0
    v_permlane16_swap_b32 v72, v76
    v_permlane16_swap_b32 v73, v77
    v_permlane16_swap_b32 v74, v78
    v_permlane16_swap_b32 v75, v79
    v_lshlrev_b32 v80, 16, v72
    v_and_b32 v82, 0xffff0000, v72
    v_lshlrev_b32 v81, 16, v76
    v_and_b32 v83, 0xffff0000, v76
    v_pk_fma_f32 v[80:81], v[80:81], v[128:129], v[144:145]
    v_pk_fma_f32 v[82:83], v[82:83], v[130:131], v[146:147]
    v_cvt_pk_bf16_f32 v80, v80, v81
    v_cvt_pk_bf16_f32 v82, v82, v83
    global_store_dword v30, v80, s[20:21] offset:-4096 nt
    global_store_dword v30, v82, s[20:21] offset:-2048 nt
    v_lshlrev_b32 v84, 16, v73
    v_and_b32 v86, 0xffff0000, v73
    v_lshlrev_b32 v85, 16, v77
    v_and_b32 v87, 0xffff0000, v77
    v_pk_fma_f32 v[84:85], v[84:85], v[132:133], v[148:149]
    v_pk_fma_f32 v[86:87], v[86:87], v[134:135], v[150:151]
    v_cvt_pk_bf16_f32 v84, v84, v85
    v_cvt_pk_bf16_f32 v86, v86, v87
    global_store_dword v30, v84, s[20:21] offset:0 nt
    global_store_dword v30, v86, s[20:21] offset:2048 nt
    v_lshlrev_b32 v88, 16, v74
    v_and_b32 v90, 0xffff0000, v74
    v_lshlrev_b32 v89, 16, v78
    v_and_b32 v91, 0xffff0000, v78
    v_pk_fma_f32 v[88:89], v[88:89], v[136:137], v[152:153]
    v_pk_fma_f32 v[90:91], v[90:91], v[138:139], v[154:155]
    v_cvt_pk_bf16_f32 v88, v88, v89
    v_cvt_pk_bf16_f32 v90, v90, v91
    global_store_dword v31, v88, s[20:21] offset:-4096 nt
    global_store_dword v31, v90, s[20:21] offset:-2048 nt
    v_lshlrev_b32 v92, 16, v75
    v_and_b32 v94, 0xffff0000, v75
    v_lshlrev_b32 v93, 16, v79
    v_and_b32 v95, 0xffff0000, v79
    v_pk_fma_f32 v[92:93], v[92:93], v[140:141], v[156:157]
    v_pk_fma_f32 v[94:95], v[94:95], v[142:143], v[158:159]
    v_cvt_pk_bf16_f32 v92, v92, v93
    v_cvt_pk_bf16_f32 v94, v94, v95
    global_store_dword v31, v92, s[20:21] offset:0 nt
    global_store_dword v31, v94, s[20:21] offset:2048 nt
    s_endpgm
L_pxretryB:
    s_add_u32 s58, s58, 1
    s_cmp_gt_u32 s58, 0x1000000
    s_cbranch_scc1 L_exit
    ds_read_b32 v34, v4
    ds_read_b128 v[36:39], v6 offset:0
    ds_read_b128 v[40:43], v6 offset:1024
    ds_read_b128 v[44:47], v6 offset:2048
    ds_read_b128 v[48:51], v6 offset:3072
    s_waitcnt lgkmcnt(0)
    v_cmp_ne_u32 vcc, 1, v34
    s_cbranch_vccnz L_pxretryB
    s_branch L_pxokB
L_yslowB:
    global_store_dwordx2 v120, v[36:37], s[36:37] sc1
    global_store_dwordx2 v121, v[40:41], s[36:37] sc1
    global_store_dwordx2 v122, v[44:45], s[36:37] sc1
    s_mov_b64 exec, s[56:57]
    global_store_dwordx4 v123, v[64:67], s[36:37] sc1
    s_mov_b64 exec, -1
    s_waitcnt vmcnt(0)
    s_branch L_ybackB
L_clrretryB:
    s_add_u32 s58, s58, 1
    s_cmp_gt_u32 s58, 0x1000000
    s_cbranch_scc1 L_exit
    global_load_dword v14, v11, s[46:47] offset:1024 sc1
    s_waitcnt vmcnt(0)
    v_cmp_ne_u32 vcc, s29, v14
    s_cbranch_vccnz L_clrretryB
    s_branch L_clrokB
L_qretryB:
    s_add_u32 s58, s58, 1
    s_cmp_gt_u32 s58, 0x1000000
    s_cbranch_scc1 L_exit
    ds_read_b32 v28, v26
    ds_read2_b32 v[248:249], v25 offset0:0 offset1:32
    ds_read2_b32 v[250:251], v25 offset0:64 offset1:96
    ds_read2_b32 v[252:253], v25 offset0:128 offset1:160
    ds_read2_b32 v[254:255], v25 offset0:192 offset1:224
    s_waitcnt lgkmcnt(0)
    v_cmp_ne_u32 vcc, 1, v28
    s_cbranch_vccnz L_qretryB
    s_branch L_qokB
.p2align 12
L_sec_aux2:
    v_mul_f32 v12, 0x3b000000, v10
    v_mul_f32 v13, 0x3b000000, v11
    v_cos_f32 v208, v12
    v_sin_f32 v216, v12
    v_add_f32 v12, v12, v13
    v_cos_f32 v209, v12
    v_sin_f32 v217, v12
    v_add_f32 v12, v12, v13
    v_cos_f32 v210, v12
    v_sin_f32 v218, v12
    v_add_f32 v12, v12, v13
    v_cos_f32 v211, v12
    v_sin_f32 v219, v12
    v_fmamk_f32 v12, v13, 0x41500000, v12
    v_cos_f32 v212, v12
    v_sin_f32 v220, v12
    v_add_f32 v12, v12, v13
    v_cos_f32 v213, v12
    v_sin_f32 v221, v12
    v_add_f32 v12, v12, v13
    v_cos_f32 v214, v12
    v_sin_f32 v222, v12
    v_add_f32 v12, v12, v13
    v_cos_f32 v215, v12
    v_sin_f32 v223, v12
    v_mul_f32 v12, 0x3d000000, v10
    v_mul_f32 v13, 0x3d000000, v11
    v_cos_f32 v100, v12
    v_sin_f32 v104, v12
    v_add_f32 v12, v12, v13
    v_cos_f32 v101, v12
    v_sin_f32 v105, v12
    v_add_f32 v12, v12, v13
    v_cos_f32 v102, v12
    v_sin_f32 v106, v12
    v_add_f32 v12, v12, v13
    v_cos_f32 v103, v12
    v_sin_f32 v107, v12
    v_cvt_pk_bf16_f32 v224, v100, v101
    v_cvt_pk_bf16_f32 v225, v102, v103
    v_cvt_pk_bf16_f32 v226, v104, v105
    v_cvt_pk_bf16_f32 v227, v106, v107
    v_xor_b32 v228, v224, v14
    v_xor_b32 v229, v225, v14
    v_xor_b32 v230, v226, v14
    v_xor_b32 v231, v227, v14
    v_xor_b32 v232, 0x80000000, v224
    v_xor_b32 v233, 0x80000000, v225
    v_xor_b32 v234, 0x80000000, v226
    v_xor_b32 v235, 0x80000000, v227
    v_xor_b32 v236, 0x80000000, v228
    v_xor_b32 v237, 0x80000000, v229
    v_xor_b32 v238, 0x80000000, v230
    v_xor_b32 v239, 0x80000000, v231
    s_waitcnt vmcnt(8)
    ds_write_b128 v247, v[128:131] offset:32
    v_mov_b32_dpp v136, v130 wave_shr:1 row_mask:0xf bank_mask:0xf
    v_mov_b32_dpp v137, v131 wave_shr:1 row_mask:0xf bank_mask:0xf
    v_alignbyte_b32 v140, v128, v137, 2
    v_alignbyte_b32 v141, v129, v128, 2
    v_alignbyte_b32 v142, v130, v129, 2
    v_alignbyte_b32 v143, v131, v130, 2
    ds_write_b128 v247, v[140:143] offset:4192
    v_mov_b32 v144, v137
    v_mov_b32 v145, v128
    v_mov_b32 v146, v129
    v_mov_b32 v147, v130
    ds_write_b128 v247, v[144:147] offset:8352
    v_alignbyte_b32 v148, v137, v136, 2
    v_alignbyte_b32 v149, v128, v137, 2
    v_alignbyte_b32 v150, v129, v128, 2
    v_alignbyte_b32 v151, v130, v129, 2
    ds_write_b128 v247, v[148:151] offset:12512
    ds_write_b128 v247, v[132:135] offset:16672
    v_mov_b32_dpp v138, v134 wave_shr:1 row_mask:0xf bank_mask:0xf
    v_mov_b32_dpp v139, v135 wave_shr:1 row_mask:0xf bank_mask:0xf
    v_alignbyte_b32 v152, v132, v139, 2
    v_alignbyte_b32 v153, v133, v132, 2
    v_alignbyte_b32 v154, v134, v133, 2
    v_alignbyte_b32 v155, v135, v134, 2
    ds_write_b128 v247, v[152:155] offset:20832
    v_mov_b32 v156, v139
    v_mov_b32 v157, v132
    v_mov_b32 v158, v133
    v_mov_b32 v159, v134
    ds_write_b128 v247, v[156:159] offset:24992
    v_alignbyte_b32 v160, v139, v138, 2
    v_alignbyte_b32 v161, v132, v139, 2
    v_alignbyte_b32 v162, v133, v132, 2
    v_alignbyte_b32 v163, v134, v133, 2
    ds_write_b128 v247, v[160:163] offset:29152
    s_waitcnt lgkmcnt(0)
    s_barrier
    s_mov_b64 exec, 1
    s_waitcnt vmcnt(0)
    global_store_dword v108, v110, s[46:47] offset:512
    s_mov_b64 exec, -1
    ds_read_b32 v121, v121
    s_setprio 1
    s_waitcnt lgkmcnt(0)
    v_cmp_ne_u32 vcc, 0, v121
    s_cbranch_vccnz L_auxslow
    s_cmp_lg_u32 s26, s32
    s_cbranch_scc1 L_noleadf
    global_load_dwordx2 v[244:245], v109, s[46:47] offset:512 sc1
    s_waitcnt vmcnt(0)
    global_load_dwordx2 v[244:245], v109, s[46:47] offset:512 sc1
    s_barrier
L_lzpollf:
    s_waitcnt vmcnt(0)
    v_cmp_ne_u32 vcc, s29, v244
    v_cmp_ne_u32 s[40:41], s29, v245
    s_nop 0
    s_or_b64 vcc, vcc, s[40:41]
    s_cbranch_scc0 L_lzokf
    global_load_dwordx2 v[244:245], v109, s[46:47] offset:512 sc1
    s_add_u32 s58, s58, 1
    s_cmp_gt_u32 s58, 0x1000000
    s_cbranch_scc1 L_exit
    s_branch L_lzpollf
L_lzokf:
    s_bfm_b64 exec, 8, 0
    global_store_dword v123, v124, s[22:23] sc1
    s_mov_b64 exec, -1
L_lzsentf:
    global_store_dwordx4 v112, v[116:119], s[52:53]
    global_store_dwordx4 v113, v[116:119], s[52:53]
    s_mov_b32 m0, 59008
    s_nop 0
    global_load_lds_dwordx4 v114, s[4:5]
    s_mov_b32 m0, 60032
    v_add_u32 v114, 8192, v114
    global_load_lds_dwordx4 v114, s[4:5]
    s_mov_b32 m0, 61056
    v_add_u32 v114, 8192, v114
    global_load_lds_dwordx4 v114, s[4:5]
    s_mov_b32 m0, 62080
    v_add_u32 v114, 8192, v114
    global_load_lds_dwordx4 v114, s[4:5]
    s_mov_b32 m0, 63104
    v_add_u32 v114, 8192, v114
    global_load_lds_dwordx4 v114, s[4:5]
    s_mov_b32 m0, 64128
    v_add_u32 v114, 8192, v114
    global_load_lds_dwordx4 v114, s[4:5]
    s_mov_b32 m0, 65152
    v_add_u32 v114, 8192, v114
    global_load_lds_dwordx4 v114, s[4:5]
    s_mov_b32 m0, 66176
    v_add_u32 v114, 8192, v114
    global_load_lds_dwordx4 v114, s[4:5]
    s_waitcnt vmcnt(8)
    s_branch L_clearedf
L_noleadf:
    s_barrier
    global_store_dwordx4 v112, v[116:119], s[52:53]
    global_store_dwordx4 v113, v[116:119], s[52:53]
    s_waitcnt vmcnt(0)
L_clearedf:
    s_load_dword s92, s[54:55], s16 glc
    s_load_dword s93, s[54:55], s17 glc
    ds_write_b32 v120, v243 offset:16
    s_mov_b64 exec, 1
    global_store_dword v108, v110, s[46:47] offset:1024
    s_mov_b64 exec, -1
L_auxjoin:
L_zpoll:
    s_waitcnt lgkmcnt(0)
    s_cmp_eq_u64 s[92:93], s[30:31]
    s_cbranch_scc1 L_zok
L_znot:
    s_load_dword s92, s[54:55], s16 glc
    s_load_dword s93, s[54:55], s17 glc
    s_add_u32 s58, s58, 1
    s_cmp_gt_u32 s58, 0x1000000
    s_cbranch_scc1 L_exit
    s_add_u32 s33, s33, 1
    s_cmp_lt_u32 s33, 3
    s_cbranch_scc1 L_zpoll
    s_waitcnt vmcnt(0)
    ds_write_b32 v120, v243 offset:32
    s_branch L_zpoll
L_zok:
    global_load_dwordx4 v[48:51], v122, s[22:23] offset:-4096 sc1
    global_load_dwordx4 v[52:55], v122, s[22:23] offset:-3968 sc1
    global_load_dwordx4 v[56:59], v122, s[22:23] offset:-3840 sc1
    global_load_dwordx4 v[60:63], v122, s[22:23] offset:-3712 sc1
    global_load_dwordx4 v[64:67], v122, s[22:23] offset:0 sc1
    global_load_dwordx4 v[68:71], v122, s[22:23] offset:128 sc1
    global_load_dwordx4 v[72:75], v122, s[22:23] offset:256 sc1
    global_load_dwordx4 v[76:79], v122, s[22:23] offset:384 sc1
    s_waitcnt vmcnt(8)
    ds_write_b32 v120, v243 offset:32
    s_waitcnt vmcnt(4)
    v_swap_b32 v52, v49
    v_swap_b32 v56, v50
    v_swap_b32 v60, v51
    v_swap_b32 v57, v54
    v_swap_b32 v61, v55
    v_swap_b32 v62, v59
    v_mfma_f32_16x16x32_bf16 v[128:131], v[192:195], v[48:51], 0
    v_mfma_f32_16x16x32_bf16 v[132:135], v[192:195], v[52:55], 0
    v_mfma_f32_16x16x32_bf16 v[136:139], v[192:195], v[56:59], 0
    v_mfma_f32_16x16x32_bf16 v[140:143], v[192:195], v[60:63], 0
    s_waitcnt vmcnt(0)
    v_swap_b32 v68, v65
    v_swap_b32 v72, v66
    v_swap_b32 v76, v67
    v_swap_b32 v73, v70
    v_swap_b32 v77, v71
    v_swap_b32 v78, v75
    v_mfma_f32_16x16x32_bf16 v[144:147], v[192:195], v[64:67], 0
    v_mfma_f32_16x16x32_bf16 v[148:151], v[192:195], v[68:71], 0
    v_mfma_f32_16x16x32_bf16 v[152:155], v[192:195], v[72:75], 0
    v_mfma_f32_16x16x32_bf16 v[156:159], v[192:195], v[76:79], 0
    s_cmp_eq_u32 s48, 0
    s_cbranch_scc1 L_two
    v_cvt_pk_bf16_f32 v80, v128, v129
    v_cvt_pk_bf16_f32 v81, v132, v133
    v_cvt_pk_bf16_f32 v82, v136, v137
    v_cvt_pk_bf16_f32 v83, v140, v141
    ds_write_b128 v125, v[80:83] offset:0
    v_cvt_pk_bf16_f32 v88, v144, v145
    v_cvt_pk_bf16_f32 v89, v148, v149
    v_cvt_pk_bf16_f32 v90, v152, v153
    v_cvt_pk_bf16_f32 v91, v156, v157
    ds_write_b128 v125, v[88:91] offset:256
    ds_write_b32 v120, v243 offset:48
    s_or_b32 s42, s2, s26
    s_setprio 0
L_zlm:
    ds_read_b32 v8, v242
    ds_read2_b32 v[48:49], v126 offset0:0 offset1:32
    ds_read2_b32 v[50:51], v126 offset0:64 offset1:96
    ds_read2_b32 v[52:53], v126 offset0:16 offset1:48
    ds_read2_b32 v[54:55], v126 offset0:80 offset1:112
    s_waitcnt lgkmcnt(4)
    v_cmp_ne_u32 vcc, 1, v8
    s_cbranch_vccz L_zlokm
L_zlwm:
    s_add_u32 s58, s58, 1
    s_cmp_gt_u32 s58, 0x1000000
    s_cbranch_scc1 L_exit
    ds_read_b32 v8, v242
    s_waitcnt lgkmcnt(0)
    v_cmp_ne_u32 vcc, 1, v8
    s_cbranch_vccnz L_zlwm
    s_branch L_zlm
L_zlokm:
    s_waitcnt lgkmcnt(2)
    v_mfma_f32_16x16x32_bf16 v[128:131], v[48:51], v[200:203], 0
    v_mfma_f32_16x16x32_bf16 v[132:135], v[48:51], v[204:207], 0
    s_waitcnt lgkmcnt(0)
    v_mfma_f32_16x16x32_bf16 v[136:139], v[52:55], v[200:203], 0
    v_mfma_f32_16x16x32_bf16 v[140:143], v[52:55], v[204:207], 0
    s_cmp_lg_u32 s42, 0
    s_cbranch_scc1 L_noepochm
    v_mov_b32 v7, 0
    s_mov_b64 exec, 1
    global_store_dword v7, v124, s[44:45]
    s_mov_b64 exec, -1
L_noepochm:
    s_bfm_b64 vcc, 1, 63
    s_nop 2
    v_pk_mul_f32 v[96:97], v[128:129], v[208:209]
    v_pk_mul_f32 v[98:99], v[132:133], v[208:209]
    v_pk_mul_f32 v[100:101], v[130:131], v[210:211]
    v_pk_mul_f32 v[102:103], v[134:135], v[210:211]
    v_pk_fma_f32 v[96:97], v[132:133], v[216:217], v[96:97]
    v_pk_fma_f32 v[98:99], v[128:129], v[216:217], v[98:99] neg_lo:[1,0,0] neg_hi:[1,0,0]
    v_pk_fma_f32 v[100:101], v[134:135], v[218:219], v[100:101]
    v_pk_fma_f32 v[102:103], v[130:131], v[218:219], v[102:103] neg_lo:[1,0,0] neg_hi:[1,0,0]
    v_cvt_pk_bf16_f32 v64, v96, v97
    v_cvt_pk_bf16_f32 v66, v98, v99
    v_cvt_pk_bf16_f32 v65, v100, v101
    v_cvt_pk_bf16_f32 v67, v102, v103
    s_nop 1
    v_mfma_f32_16x16x32_bf16 v[160:163], v[64:67], v[224:227], 0
    v_mfma_f32_16x16x32_bf16 v[164:167], v[64:67], v[232:235], 0
    v_pk_mul_f32 v[96:97], v[136:137], v[212:213]
    v_pk_mul_f32 v[98:99], v[140:141], v[212:213]
    v_pk_mul_f32 v[100:101], v[138:139], v[214:215]
    v_pk_mul_f32 v[102:103], v[142:143], v[214:215]
    v_pk_fma_f32 v[96:97], v[140:141], v[220:221], v[96:97]
    v_pk_fma_f32 v[98:99], v[136:137], v[220:221], v[98:99] neg_lo:[1,0,0] neg_hi:[1,0,0]
    v_pk_fma_f32 v[100:101], v[142:143], v[222:223], v[100:101]
    v_pk_fma_f32 v[102:103], v[138:139], v[222:223], v[102:103] neg_lo:[1,0,0] neg_hi:[1,0,0]
    v_cvt_pk_bf16_f32 v68, v96, v97
    v_cvt_pk_bf16_f32 v70, v98, v99
    v_cvt_pk_bf16_f32 v69, v100, v101
    v_cvt_pk_bf16_f32 v71, v102, v103
    s_nop 1
    v_mfma_f32_16x16x32_bf16 v[160:163], v[68:71], v[228:231], v[160:163]
    v_mfma_f32_16x16x32_bf16 v[164:167], v[68:71], v[236:239], v[164:167]
    s_nop 6
    ds_bpermute_b32 v24, v251, v160
    ds_bpermute_b32 v25, v251, v164
    v_cvt_pk_bf16_f32 v16, v160, v161
    v_cvt_pk_bf16_f32 v17, v162, v163
    global_store_dwordx2 v240, v[16:17], s[20:21] offset:1024 nt
    v_cvt_pk_bf16_f32 v18, v164, v165
    v_cvt_pk_bf16_f32 v19, v166, v167
    global_store_dwordx2 v240, v[18:19], s[20:21] offset:1536 nt
    v_cvt_pk_bf16_f32 v21, v162, v161
    v_cvt_pk_bf16_f32 v23, v166, v165
    s_waitcnt lgkmcnt(0)
    v_cndmask_b32 v26, v24, v25, vcc
    v_cndmask_b32 v27, v25, v24, vcc
    v_cvt_pk_bf16_f32 v20, v26, v163
    global_store_dwordx2 v250, v[20:21], s[20:21] offset:2040 nt
    v_cvt_pk_bf16_f32 v22, v27, v167
    global_store_dwordx2 v250, v[22:23], s[20:21] offset:1528 nt
    s_endpgm
L_two:
    s_nop 5
    v_cvt_pk_bf16_f32 v80, v128, v129
    v_cvt_pk_bf16_f32 v81, v132, v133
    v_cvt_pk_bf16_f32 v82, v136, v137
    v_cvt_pk_bf16_f32 v83, v140, v141
    ds_write_b128 v125, v[80:83] offset:0
    v_cvt_pk_bf16_f32 v84, v130, v131
    v_cvt_pk_bf16_f32 v85, v134, v135
    v_cvt_pk_bf16_f32 v86, v138, v139
    v_cvt_pk_bf16_f32 v87, v142, v143
    ds_write_b128 v125, v[84:87] offset:2304
    v_cvt_pk_bf16_f32 v88, v144, v145
    v_cvt_pk_bf16_f32 v89, v148, v149
    v_cvt_pk_bf16_f32 v90, v152, v153
    v_cvt_pk_bf16_f32 v91, v156, v157
    ds_write_b128 v125, v[88:91] offset:256
    v_cvt_pk_bf16_f32 v92, v146, v147
    v_cvt_pk_bf16_f32 v93, v150, v151
    v_cvt_pk_bf16_f32 v94, v154, v155
    v_cvt_pk_bf16_f32 v95, v158, v159
    ds_write_b128 v125, v[92:95] offset:2560
    ds_write_b32 v120, v243 offset:48
    s_or_b32 s42, s2, s26
    s_setprio 0
L_zlt:
    ds_read_b32 v8, v242
    ds_read2_b32 v[48:49], v126 offset0:0 offset1:32
    ds_read2_b32 v[50:51], v126 offset0:64 offset1:96
    ds_read2_b32 v[52:53], v126 offset0:16 offset1:48
    ds_read2_b32 v[54:55], v126 offset0:80 offset1:112
    ds_read2_b32 v[56:57], v249 offset0:0 offset1:32
    ds_read2_b32 v[58:59], v249 offset0:64 offset1:96
    ds_read2_b32 v[60:61], v249 offset0:16 offset1:48
    ds_read2_b32 v[62:63], v249 offset0:80 offset1:112
    s_waitcnt lgkmcnt(8)
    v_cmp_ne_u32 vcc, 1, v8
    s_cbranch_vccz L_zlokt
L_zlwt:
    s_add_u32 s58, s58, 1
    s_cmp_gt_u32 s58, 0x1000000
    s_cbranch_scc1 L_exit
    ds_read_b32 v8, v242
    s_waitcnt lgkmcnt(0)
    v_cmp_ne_u32 vcc, 1, v8
    s_cbranch_vccnz L_zlwt
    s_branch L_zlt
L_zlokt:
    s_waitcnt lgkmcnt(6)
    v_mfma_f32_16x16x32_bf16 v[128:131], v[48:51], v[200:203], 0
    v_mfma_f32_16x16x32_bf16 v[132:135], v[48:51], v[204:207], 0
    s_waitcnt lgkmcnt(4)
    v_mfma_f32_16x16x32_bf16 v[136:139], v[52:55], v[200:203], 0
    v_mfma_f32_16x16x32_bf16 v[140:143], v[52:55], v[204:207], 0
    s_waitcnt lgkmcnt(2)
    v_mfma_f32_16x16x32_bf16 v[144:147], v[56:59], v[200:203], 0
    v_mfma_f32_16x16x32_bf16 v[148:151], v[56:59], v[204:207], 0
    s_waitcnt lgkmcnt(0)
    v_mfma_f32_16x16x32_bf16 v[152:155], v[60:63], v[200:203], 0
    v_mfma_f32_16x16x32_bf16 v[156:159], v[60:63], v[204:207], 0
    v_pk_mul_f32 v[96:97], v[128:129], v[208:209]
    v_pk_mul_f32 v[98:99], v[132:133], v[208:209]
    v_pk_mul_f32 v[100:101], v[130:131], v[210:211]
    v_pk_mul_f32 v[102:103], v[134:135], v[210:211]
    v_pk_fma_f32 v[96:97], v[132:133], v[216:217], v[96:97]
    v_pk_fma_f32 v[98:99], v[128:129], v[216:217], v[98:99] neg_lo:[1,0,0] neg_hi:[1,0,0]
    v_pk_fma_f32 v[100:101], v[134:135], v[218:219], v[100:101]
    v_pk_fma_f32 v[102:103], v[130:131], v[218:219], v[102:103] neg_lo:[1,0,0] neg_hi:[1,0,0]
    v_cvt_pk_bf16_f32 v64, v96, v97
    v_cvt_pk_bf16_f32 v66, v98, v99
    v_cvt_pk_bf16_f32 v65, v100, v101
    v_cvt_pk_bf16_f32 v67, v102, v103
    s_nop 1
    v_mfma_f32_16x16x32_bf16 v[160:163], v[64:67], v[224:227], 0
    v_mfma_f32_16x16x32_bf16 v[164:167], v[64:67], v[232:235], 0
    v_pk_mul_f32 v[96:97], v[136:137], v[212:213]
    v_pk_mul_f32 v[98:99], v[140:141], v[212:213]
    v_pk_mul_f32 v[100:101], v[138:139], v[214:215]
    v_pk_mul_f32 v[102:103], v[142:143], v[214:215]
    v_pk_fma_f32 v[96:97], v[140:141], v[220:221], v[96:97]
    v_pk_fma_f32 v[98:99], v[136:137], v[220:221], v[98:99] neg_lo:[1,0,0] neg_hi:[1,0,0]
    v_pk_fma_f32 v[100:101], v[142:143], v[222:223], v[100:101]
    v_pk_fma_f32 v[102:103], v[138:139], v[222:223], v[102:103] neg_lo:[1,0,0] neg_hi:[1,0,0]
    v_cvt_pk_bf16_f32 v68, v96, v97
    v_cvt_pk_bf16_f32 v70, v98, v99
    v_cvt_pk_bf16_f32 v69, v100, v101
    v_cvt_pk_bf16_f32 v71, v102, v103
    s_nop 1
    v_mfma_f32_16x16x32_bf16 v[160:163], v[68:71], v[228:231], v[160:163]
    v_mfma_f32_16x16x32_bf16 v[164:167], v[68:71], v[236:239], v[164:167]
    v_pk_mul_f32 v[96:97], v[144:145], v[208:209]
    v_pk_mul_f32 v[98:99], v[148:149], v[208:209]
    v_pk_mul_f32 v[100:101], v[146:147], v[210:211]
    v_pk_mul_f32 v[102:103], v[150:151], v[210:211]
    v_pk_fma_f32 v[96:97], v[148:149], v[216:217], v[96:97]
    v_pk_fma_f32 v[98:99], v[144:145], v[216:217], v[98:99] neg_lo:[1,0,0] neg_hi:[1,0,0]
    v_pk_fma_f32 v[100:101], v[150:151], v[218:219], v[100:101]
    v_pk_fma_f32 v[102:103], v[146:147], v[218:219], v[102:103] neg_lo:[1,0,0] neg_hi:[1,0,0]
    v_cvt_pk_bf16_f32 v72, v96, v97
    v_cvt_pk_bf16_f32 v74, v98, v99
    v_cvt_pk_bf16_f32 v73, v100, v101
    v_cvt_pk_bf16_f32 v75, v102, v103
    v_cvt_pk_bf16_f32 v16, v160, v161
    v_cvt_pk_bf16_f32 v17, v162, v163
    global_store_dwordx2 v240, v[16:17], s[20:21] offset:1024 nt
    v_cvt_pk_bf16_f32 v18, v164, v165
    v_cvt_pk_bf16_f32 v19, v166, v167
    global_store_dwordx2 v240, v[18:19], s[20:21] offset:1536 nt
    v_mfma_f32_16x16x32_bf16 v[168:171], v[72:75], v[224:227], 0
    v_mfma_f32_16x16x32_bf16 v[172:175], v[72:75], v[232:235], 0
    v_pk_mul_f32 v[96:97], v[152:153], v[212:213]
    v_pk_mul_f32 v[98:99], v[156:157], v[212:213]
    v_pk_mul_f32 v[100:101], v[154:155], v[214:215]
    v_pk_mul_f32 v[102:103], v[158:159], v[214:215]
    v_pk_fma_f32 v[96:97], v[156:157], v[220:221], v[96:97]
    v_pk_fma_f32 v[98:99], v[152:153], v[220:221], v[98:99] neg_lo:[1,0,0] neg_hi:[1,0,0]
    v_pk_fma_f32 v[100:101], v[158:159], v[222:223], v[100:101]
    v_pk_fma_f32 v[102:103], v[154:155], v[222:223], v[102:103] neg_lo:[1,0,0] neg_hi:[1,0,0]
    v_cvt_pk_bf16_f32 v76, v96, v97
    v_cvt_pk_bf16_f32 v78, v98, v99
    v_cvt_pk_bf16_f32 v77, v100, v101
    v_cvt_pk_bf16_f32 v79, v102, v103
    s_nop 1
    v_mfma_f32_16x16x32_bf16 v[168:171], v[76:79], v[228:231], v[168:171]
    v_mfma_f32_16x16x32_bf16 v[172:175], v[76:79], v[236:239], v[172:175]
    s_cmp_lg_u32 s42, 0
    s_cbranch_scc1 L_noepocht
    v_mov_b32 v7, 0
    s_mov_b64 exec, 1
    global_store_dword v7, v124, s[44:45]
    s_mov_b64 exec, -1
L_noepocht:
    s_nop 5
    v_cvt_pk_bf16_f32 v20, v168, v169
    v_cvt_pk_bf16_f32 v21, v170, v171
    global_store_dwordx2 v241, v[20:21], s[20:21] offset:1024 nt
    v_cvt_pk_bf16_f32 v22, v172, v173
    v_cvt_pk_bf16_f32 v23, v174, v175
    global_store_dwordx2 v241, v[22:23], s[20:21] offset:1536 nt
L_exit:
    s_endpgm
L_auxslow:
    s_mov_b32 s29, s27
    v_mov_b32 v110, s27
    s_add_u32 s52, s22, 6291456
    s_addc_u32 s53, s23, 0
    s_mov_b64 exec, 1
    global_store_dword v108, v110, s[46:47] offset:2048 sc1
    s_mov_b64 exec, -1
    s_cmp_lg_u32 s26, s32
    s_cbranch_scc1 L_noleads
    global_load_dwordx2 v[244:245], v109, s[46:47] offset:2048 sc1
    s_waitcnt vmcnt(0)
    global_load_dwordx2 v[244:245], v109, s[46:47] offset:2048 sc1
    s_barrier
L_lzpolls:
    s_waitcnt vmcnt(0)
    v_cmp_ne_u32 vcc, s29, v244
    v_cmp_ne_u32 s[40:41], s29, v245
    s_nop 0
    s_or_b64 vcc, vcc, s[40:41]
    s_cbranch_scc0 L_lzoks
    global_load_dwordx2 v[244:245], v109, s[46:47] offset:2048 sc1
    s_add_u32 s58, s58, 1
    s_cmp_gt_u32 s58, 0x1000000
    s_cbranch_scc1 L_exit
    s_branch L_lzpolls
L_lzoks:
    s_bfm_b64 exec, 8, 0
    global_store_dword v123, v124, s[22:23] sc1
    s_mov_b64 exec, -1
L_lzsents:
    global_store_dwordx4 v112, v[116:119], s[52:53] sc1
    global_store_dwordx4 v113, v[116:119], s[52:53] sc1
    s_mov_b32 m0, 59008
    s_nop 0
    global_load_lds_dwordx4 v114, s[4:5]
    s_mov_b32 m0, 60032
    v_add_u32 v114, 8192, v114
    global_load_lds_dwordx4 v114, s[4:5]
    s_mov_b32 m0, 61056
    v_add_u32 v114, 8192, v114
    global_load_lds_dwordx4 v114, s[4:5]
    s_mov_b32 m0, 62080
    v_add_u32 v114, 8192, v114
    global_load_lds_dwordx4 v114, s[4:5]
    s_mov_b32 m0, 63104
    v_add_u32 v114, 8192, v114
    global_load_lds_dwordx4 v114, s[4:5]
    s_mov_b32 m0, 64128
    v_add_u32 v114, 8192, v114
    global_load_lds_dwordx4 v114, s[4:5]
    s_mov_b32 m0, 65152
    v_add_u32 v114, 8192, v114
    global_load_lds_dwordx4 v114, s[4:5]
    s_mov_b32 m0, 66176
    v_add_u32 v114, 8192, v114
    global_load_lds_dwordx4 v114, s[4:5]
    s_waitcnt vmcnt(8)
    s_branch L_cleareds
L_noleads:
    s_barrier
    global_store_dwordx4 v112, v[116:119], s[52:53] sc1
    global_store_dwordx4 v113, v[116:119], s[52:53] sc1
    s_waitcnt vmcnt(0)
L_cleareds:
    s_load_dword s92, s[54:55], s16 glc
    s_load_dword s93, s[54:55], s17 glc
    ds_write_b32 v120, v243 offset:16
    s_mov_b64 exec, 1
    global_store_dword v108, v110, s[46:47] offset:2560 sc1
    s_mov_b64 exec, -1
    s_branch L_auxjoin
L_code_end:
.section .rodata,"a"
.p2align 6
.amdhsa_kernel concat_heads__ssm_conv_h3__spectral_fnet__prompt_kernel
  .amdhsa_next_free_vgpr 256
  .amdhsa_next_free_sgpr 100
  .amdhsa_accum_offset 256
  .amdhsa_group_segment_fixed_size 0
  .amdhsa_kernarg_size 112
  .amdhsa_user_sgpr_count 2
  .amdhsa_user_sgpr_kernarg_segment_ptr 1
  .amdhsa_system_sgpr_workgroup_id_x 1
  .amdhsa_float_denorm_mode_32 3
.end_amdhsa_kernel
```
